```python
import torch

def _softmax(x, axis=-1):
    return torch.softmax(x, dim=axis)
def _gelu(x):
    return torch.nn.functional.gelu(x, approximate="tanh")
def _silu(x):
    return torch.nn.functional.silu(x)
def _sigmoid(x):
    return torch.sigmoid(x)
def _layernorm(x, axis=-1, eps=1e-5):
    m = x.mean(dim=axis, keepdim=True)
    v = x.var(dim=axis, keepdim=True, unbiased=False)
    return (x - m) / torch.sqrt(v + eps)
def _scatter_add(tgt, idx, src, axis=0):
    return tgt.clone().index_add_(axis, idx, src)
def _segment_sum(src, seg, n):
    out = torch.zeros((n,) + src.shape[1:], dtype=src.dtype)
    return out.index_add_(0, seg, src)
def _pad(x, pw):
    flat = tuple(v for pair in reversed(pw) for v in pair)
    return torch.nn.functional.pad(x, flat)

kernel_name = 'gated_mix__spectral_fnet__dense_activation_relu__prompt'

def setup_inputs():

    _w = (lambda a: (lambda t: t.to(torch.bfloat16) if t.is_floating_point() else t)(torch.as_tensor(a)))
    def _A_setup():
        B, S, D = 1, 2048, 1024
        ns = torch.arange(S)[:, None] * torch.arange(S)[None, :]
        nd = torch.arange(D)[:, None] * torch.arange(D)[None, :]
        Ws_re = torch.cos(-2.0 * torch.pi * ns / S).to(float)
        Ws_im = torch.sin(-2.0 * torch.pi * ns / S).to(float)
        Wd_re = torch.cos(-2.0 * torch.pi * nd / D).to(float)
        Wd_im = torch.sin(-2.0 * torch.pi * nd / D).to(float)
        return {
            "x": _w((lambda *s: torch.randn(*s, dtype=torch.bfloat16) * 0.05)(B, S, D)),
            "dft_seq_re": _w(Ws_re),
            "dft_seq_im": _w(Ws_im),
            "dft_hid_re": _w(Wd_re),
            "dft_hid_im": _w(Wd_im),
        }
    _A_in = _A_setup()

    def _B_setup():
        B, S, D, Dff = 1, 2048, 1024, 3584
        return {
            "x": _w((lambda *s: torch.randn(*s, dtype=torch.bfloat16) * 0.05)(B, S, D)),
            "w1": _w((lambda *s: torch.randn(*s, dtype=torch.bfloat16) * 0.4)(D, Dff)),
            "w2": _w((lambda *s: torch.randn(*s, dtype=torch.bfloat16) * 0.4)(Dff, D)),
        }
    _B_in = _B_setup()

    return {
        "A_x": _A_in["x"],
        "A_dft_seq_re": _A_in["dft_seq_re"],
        "A_dft_seq_im": _A_in["dft_seq_im"],
        "A_dft_hid_re": _A_in["dft_hid_re"],
        "A_dft_hid_im": _A_in["dft_hid_im"],
        "B_x": _B_in["x"],
        "B_w1": _B_in["w1"],
        "B_w2": _B_in["w2"],
        "gate_w": _w((lambda *s: torch.randn(*s, dtype=torch.bfloat16) * 0.05)(1024) * 16.0),
    }

def reference(A_x, A_dft_seq_re, A_dft_seq_im, A_dft_hid_re, A_dft_hid_im, B_x, B_w1, B_w2, gate_w):
    def _A_ref(x, dft_seq_re, dft_seq_im, dft_hid_re, dft_hid_im):
        a = torch.einsum("bsd,ed->bse", x, dft_hid_re)
        b = torch.einsum("bsd,ed->bse", x, dft_hid_im)
        y = torch.einsum("ts,bse->bte", dft_seq_re, a) - torch.einsum("ts,bse->bte", dft_seq_im, b)
        return y

    def _B_ref(x, w1, w2):
        h = torch.einsum("bsd,df->bsf", x, w1)
        zero = torch.zeros_like(h)
        h = torch.maximum(h, zero)
        return torch.einsum("bsf,fd->bsd", h, w2)

    x = A_x
    g = _sigmoid((x * gate_w).sum(-1, keepdims=True))
    a = _A_ref(x, A_dft_seq_re, A_dft_seq_im, A_dft_hid_re, A_dft_hid_im)
    b = _B_ref(x, B_w1, B_w2)
    return g * a + (1 - g) * b
```

```asm
; @launch grid=(256,1,1) block=(512,1,1) lds=163840
.amdgcn_target "amdgcn-amd-amdhsa--gfx950"
.text
.globl gated_mix__spectral_fnet__dense_activation_relu__prompt_kernel
.p2align 8
.type gated_mix__spectral_fnet__dense_activation_relu__prompt_kernel,@function
gated_mix__spectral_fnet__dense_activation_relu__prompt_kernel:
s_cmp_ge_u32 s2, 256
s_cbranch_scc1 L_end
s_load_dwordx2 s[4:5], s[0:1], 0
s_load_dwordx2 s[6:7], s[0:1], 48
s_load_dwordx2 s[8:9], s[0:1], 88
s_load_dwordx2 s[10:11], s[0:1], 56
s_load_dwordx2 s[12:13], s[0:1], 64
s_load_dwordx4 s[16:19], s[0:1], 24
s_load_dwordx4 s[96:99], s[0:1], 72
s_getpc_b64 s[14:15]
L_pc:
v_lshlrev_b32 v5, 4, v0
s_sub_u32 s14, s14, L_pc-gated_mix__spectral_fnet__dense_activation_relu__prompt_kernel
s_subb_u32 s15, s15, 0
s_mov_b32 s31, L_code_end-gated_mix__spectral_fnet__dense_activation_relu__prompt_kernel-16
v_min_u32 v6, s31, v5
global_load_dwordx4 v[244:247], v6, s[14:15]
v_add_u32 v5, 0x2000, v5
v_min_u32 v6, s31, v5
global_load_dwordx4 v[244:247], v6, s[14:15]
v_add_u32 v5, 0x2000, v5
v_min_u32 v6, s31, v5
global_load_dwordx4 v[244:247], v6, s[14:15]
v_add_u32 v5, 0x2000, v5
s_and_b32 s20, s2, 7
s_lshr_b32 s21, s2, 3
s_and_b32 s30, s20, 1
s_lshl_b32 s30, s30, 3
s_and_b32 s31, s21, 7
s_add_u32 s22, s30, s31
s_lshr_b32 s31, s20, 1
s_lshr_b32 s33, s21, 3
s_lshr_b32 s86, s31, 1
s_lshl_b32 s32, s86, 3
s_lshl_b32 s34, s33, 1
s_add_u32 s32, s32, s34
s_and_b32 s34, s31, 1
s_add_u32 s23, s32, s34
s_lshl_b32 s34, s34, 2
s_add_u32 s85, s34, s33
s_and_b32 s29, s21, 1
s_lshr_b32 s32, s21, 1
s_lshl_b32 s31, s31, 1
s_lshr_b32 s33, s32, 3
s_add_u32 s31, s31, s33
s_lshl_b32 s31, s31, 4
s_and_b32 s32, s32, 7
s_add_u32 s31, s31, s32
s_add_u32 s28, s31, s30
s_lshr_b32 s33, s21, 3
s_cmp_eq_u32 s33, 0
s_cselect_b32 s101, 1, 0
v_and_b32 v1, 63, v0
v_lshrrev_b32 v2, 6, v0
v_and_b32 v3, 15, v1
v_lshrrev_b32 v4, 4, v1
v_readfirstlane_b32 s25, v2
v_lshrrev_b32 v10, 1, v1
v_lshlrev_b32 v10, 6, v10
v_xor_b32 v11, v1, v4
v_and_b32 v11, 1, v11
v_lshl_add_u32 v10, v11, 5, v10
s_cmp_lt_u32 s25, 4
s_cbranch_scc1 L_cstart
s_sub_u32 s95, s25, 4
s_cmp_lt_u32 s95, 2
s_cbranch_scc1 L_sstart
s_sub_u32 s35, s95, 2
s_mov_b32 s3, 2
v_lshrrev_b32 v5, 2, v1
v_lshlrev_b32 v5, 6, v5
v_lshrrev_b32 v6, 5, v1
v_lshlrev_b32 v6, 1, v6
v_and_b32 v7, 3, v1
v_xor_b32 v6, v6, v7
v_lshl_add_u32 v198, v6, 4, v5
v_lshlrev_b32 v200, 4, v1
v_lshlrev_b32 v5, 2, v1
v_mov_b32 v12, 0
s_lshl_b32 s31, s22, 1
s_add_u32 s83, s86, s31
s_lshl_b32 s83, s83, 8
s_waitcnt lgkmcnt(0)
s_mov_b32 s36, s4
s_mov_b32 s37, s5
s_mov_b32 s38, 0x400000
s_mov_b32 s39, 0x20000
s_mov_b32 s40, s6
s_mov_b32 s41, s7
s_mov_b32 s42, 0x700000
s_mov_b32 s43, 0x20000
s_mov_b32 s76, s98
s_mov_b32 s77, s99
s_mov_b32 s78, 0x100
s_mov_b32 s79, 0x20000
s_cmp_eq_u32 s101, 1
s_cbranch_scc1 L_h_early
s_mov_b32 s24, 0
s_mov_b32 s60, s12
s_mov_b32 s61, s13
s_mov_b32 s62, 0x800
s_mov_b32 s63, 0x20000
buffer_load_dwordx4 v[232:235], v10, s[60:63], 0 offen
buffer_load_dwordx4 v[236:239], v10, s[60:63], 0 offen offset:16
s_sub_u32 s35, s95, 2
s_lshl_b32 s31, s35, 3
s_lshl_b32 s32, s31, 7
s_add_u32 s32, s32, s28
s_lshl_b32 s32, s32, 11
s_lshl_b32 s33, s31, 11
s_add_u32 s33, s33, 131072
s_add_u32 m0, s33, 0
s_add_u32 s34, s32, 0
buffer_load_dwordx4 v198, s[36:39], s34 offen lds
s_add_u32 m0, s33, 1024
s_add_u32 s34, s32, 1024
buffer_load_dwordx4 v198, s[36:39], s34 offen lds
s_add_u32 m0, s33, 2048
s_add_u32 s34, s32, 262144
buffer_load_dwordx4 v198, s[36:39], s34 offen lds
s_add_u32 m0, s33, 3072
s_add_u32 s34, s32, 263168
buffer_load_dwordx4 v198, s[36:39], s34 offen lds
s_add_u32 m0, s33, 4096
s_add_u32 s34, s32, 524288
buffer_load_dwordx4 v198, s[36:39], s34 offen lds
s_add_u32 m0, s33, 5120
s_add_u32 s34, s32, 525312
buffer_load_dwordx4 v198, s[36:39], s34 offen lds
s_add_u32 m0, s33, 6144
s_add_u32 s34, s32, 786432
buffer_load_dwordx4 v198, s[36:39], s34 offen lds
s_add_u32 m0, s33, 7168
s_add_u32 s34, s32, 787456
buffer_load_dwordx4 v198, s[36:39], s34 offen lds
s_add_u32 m0, s33, 8192
s_add_u32 s34, s32, 1048576
buffer_load_dwordx4 v198, s[36:39], s34 offen lds
s_add_u32 m0, s33, 9216
s_add_u32 s34, s32, 1049600
buffer_load_dwordx4 v198, s[36:39], s34 offen lds
s_add_u32 m0, s33, 10240
s_add_u32 s34, s32, 1310720
buffer_load_dwordx4 v198, s[36:39], s34 offen lds
s_add_u32 m0, s33, 11264
s_add_u32 s34, s32, 1311744
buffer_load_dwordx4 v198, s[36:39], s34 offen lds
s_add_u32 m0, s33, 12288
s_add_u32 s34, s32, 1572864
buffer_load_dwordx4 v198, s[36:39], s34 offen lds
s_add_u32 m0, s33, 13312
s_add_u32 s34, s32, 1573888
buffer_load_dwordx4 v198, s[36:39], s34 offen lds
s_add_u32 m0, s33, 14336
s_add_u32 s34, s32, 1835008
buffer_load_dwordx4 v198, s[36:39], s34 offen lds
s_add_u32 m0, s33, 15360
s_add_u32 s34, s32, 1836032
buffer_load_dwordx4 v198, s[36:39], s34 offen lds
s_branch L_fft
L_h_early:
s_add_u32 s68, s8, 0x1900000
s_addc_u32 s69, s9, 0
s_mov_b32 s70, 0x2000
s_mov_b32 s71, 0x20000
s_and_b32 s30, s23, 7
s_or_b32 s30, s30, s35
s_cmp_eq_u32 s30, 0
s_cselect_b32 s24, 1, 0
s_cbranch_scc0 L_noreset
buffer_store_dword v12, v5, s[68:71], s83 offen sc1
L_noreset:
s_sub_u32 s35, s95, 2
s_lshl_b32 s31, s2, 14
s_lshl_b32 s32, s35, 13
s_add_u32 s31, s31, s32
buffer_load_dwordx4 v[244:247], v200, s[36:39], s31 offen offset:0
buffer_load_dwordx4 v[244:247], v200, s[36:39], s31 offen offset:1024
buffer_load_dwordx4 v[244:247], v200, s[36:39], s31 offen offset:2048
buffer_load_dwordx4 v[244:247], v200, s[36:39], s31 offen offset:3072
s_add_u32 s31, s31, 4096
buffer_load_dwordx4 v[244:247], v200, s[36:39], s31 offen offset:0
buffer_load_dwordx4 v[244:247], v200, s[36:39], s31 offen offset:1024
buffer_load_dwordx4 v[244:247], v200, s[36:39], s31 offen offset:2048
buffer_load_dwordx4 v[244:247], v200, s[36:39], s31 offen offset:3072
s_mul_i32 s31, s2, 28672
s_mul_i32 s32, s35, 14336
s_add_u32 s31, s31, s32
buffer_load_dwordx4 v[244:247], v200, s[40:43], s31 offen offset:0
buffer_load_dwordx4 v[244:247], v200, s[40:43], s31 offen offset:1024
buffer_load_dwordx4 v[244:247], v200, s[40:43], s31 offen offset:2048
buffer_load_dwordx4 v[244:247], v200, s[40:43], s31 offen offset:3072
s_add_u32 s31, s31, 4096
buffer_load_dwordx4 v[244:247], v200, s[40:43], s31 offen offset:0
buffer_load_dwordx4 v[244:247], v200, s[40:43], s31 offen offset:1024
buffer_load_dwordx4 v[244:247], v200, s[40:43], s31 offen offset:2048
buffer_load_dwordx4 v[244:247], v200, s[40:43], s31 offen offset:3072
s_add_u32 s31, s31, 4096
buffer_load_dwordx4 v[244:247], v200, s[40:43], s31 offen offset:0
buffer_load_dwordx4 v[244:247], v200, s[40:43], s31 offen offset:1024
buffer_load_dwordx4 v[244:247], v200, s[40:43], s31 offen offset:2048
buffer_load_dwordx4 v[244:247], v200, s[40:43], s31 offen offset:3072
s_add_u32 s31, s31, 4096
buffer_load_dwordx4 v[244:247], v200, s[40:43], s31 offen offset:0
buffer_load_dwordx4 v[244:247], v200, s[40:43], s31 offen offset:1024
s_branch L_help_g1
L_sstart:
s_mov_b32 s3, 1
s_lshl_b32 s31, s95, 6
v_lshrrev_b32 v5, 3, v1
v_add_u32 v5, s31, v5
v_lshlrev_b32 v5, 4, v5
v_add_u32 v5, s22, v5
v_lshlrev_b32 v5, 11, v5
v_and_b32 v6, 7, v1
v_xor_b32 v6, v6, v4
v_lshl_add_u32 v7, v6, 4, v5
v_xor_b32 v6, 4, v6
v_lshl_add_u32 v8, v6, 4, v5
v_add_u32 v176, 0, v7
v_add_u32 v177, 261120, v8
v_add_u32 v178, 522240, v7
v_add_u32 v179, 783360, v8
v_add_u32 v180, 1048576, v7
v_add_u32 v181, 1309696, v8
v_add_u32 v182, 1570816, v7
v_add_u32 v183, 1831936, v8
s_mul_i32 s31, s23, 448
s_mul_i32 s32, s95, 229376
s_add_u32 s31, s31, s32
s_mov_b32 s33, 7168
v_cmp_le_u32 vcc, 28, v1
v_cmp_le_u32 s[34:35], 56, v1
v_mov_b32 v6, v1
v_cndmask_b32 v5, 0, 1, vcc
v_cndmask_b32 v7, 0, 1, s[34:35]
v_add_u32 v5, v5, v7
v_mul_u32_u24 v7, 28, v5
v_sub_u32 v6, v1, v7
s_lshl_b32 s87, s95, 13
s_mul_i32 s88, s95, 14336
s_add_u32 s88, s88, 16384
s_mov_b32 s89, 0
s_mov_b32 s90, 0
s_mov_b32 s91, 0
v_lshrrev_b32 v7, 2, v5
v_and_b32 v7, 2, v7
v_xor_b32 v7, v7, v6
v_lshlrev_b32 v7, 4, v7
v_mad_u32_u24 v7, v5, s33, v7
v_add_u32 v7, s31, v7
v_subrev_u32 v184, 0, v7
v_add_u32 v6, 8, v6
v_cmp_le_u32 vcc, 28, v6
v_subrev_u32 v7, 28, v6
v_add_u32 v5, 2, v5
v_cndmask_b32 v6, v6, v7, vcc
v_addc_co_u32 v5, vcc, 0, v5, vcc
v_lshrrev_b32 v7, 2, v5
v_and_b32 v7, 2, v7
v_xor_b32 v7, v7, v6
v_lshlrev_b32 v7, 4, v7
v_mad_u32_u24 v7, v5, s33, v7
v_add_u32 v7, s31, v7
v_subrev_u32 v185, 1024, v7
v_add_u32 v6, 8, v6
v_cmp_le_u32 vcc, 28, v6
v_subrev_u32 v7, 28, v6
v_add_u32 v5, 2, v5
v_cndmask_b32 v6, v6, v7, vcc
v_addc_co_u32 v5, vcc, 0, v5, vcc
v_lshrrev_b32 v7, 2, v5
v_and_b32 v7, 2, v7
v_xor_b32 v7, v7, v6
v_lshlrev_b32 v7, 4, v7
v_mad_u32_u24 v7, v5, s33, v7
v_add_u32 v7, s31, v7
v_subrev_u32 v186, 2048, v7
v_add_u32 v6, 8, v6
v_cmp_le_u32 vcc, 28, v6
v_subrev_u32 v7, 28, v6
v_add_u32 v5, 2, v5
v_cndmask_b32 v6, v6, v7, vcc
v_addc_co_u32 v5, vcc, 0, v5, vcc
v_lshrrev_b32 v7, 2, v5
v_and_b32 v7, 2, v7
v_xor_b32 v7, v7, v6
v_lshlrev_b32 v7, 4, v7
v_mad_u32_u24 v7, v5, s33, v7
v_add_u32 v7, s31, v7
v_subrev_u32 v187, 3072, v7
v_add_u32 v6, 8, v6
v_cmp_le_u32 vcc, 28, v6
v_subrev_u32 v7, 28, v6
v_add_u32 v5, 2, v5
v_cndmask_b32 v6, v6, v7, vcc
v_addc_co_u32 v5, vcc, 0, v5, vcc
v_lshrrev_b32 v7, 2, v5
v_and_b32 v7, 2, v7
v_xor_b32 v7, v7, v6
v_lshlrev_b32 v7, 4, v7
v_mad_u32_u24 v7, v5, s33, v7
v_add_u32 v7, s31, v7
v_subrev_u32 v188, 0, v7
v_add_u32 v6, 8, v6
v_cmp_le_u32 vcc, 28, v6
v_subrev_u32 v7, 28, v6
v_add_u32 v5, 2, v5
v_cndmask_b32 v6, v6, v7, vcc
v_addc_co_u32 v5, vcc, 0, v5, vcc
v_lshrrev_b32 v7, 2, v5
v_and_b32 v7, 2, v7
v_xor_b32 v7, v7, v6
v_lshlrev_b32 v7, 4, v7
v_mad_u32_u24 v7, v5, s33, v7
v_add_u32 v7, s31, v7
v_subrev_u32 v189, 1024, v7
v_add_u32 v6, 8, v6
v_cmp_le_u32 vcc, 28, v6
v_subrev_u32 v7, 28, v6
v_add_u32 v5, 2, v5
v_cndmask_b32 v6, v6, v7, vcc
v_addc_co_u32 v5, vcc, 0, v5, vcc
v_lshrrev_b32 v7, 2, v5
v_and_b32 v7, 2, v7
v_xor_b32 v7, v7, v6
v_lshlrev_b32 v7, 4, v7
v_mad_u32_u24 v7, v5, s33, v7
v_add_u32 v7, s31, v7
v_subrev_u32 v190, 2048, v7
v_add_u32 v191, 111616, v184
v_add_u32 v192, 115712, v185
v_add_u32 v193, 115712, v186
v_add_u32 v194, 115712, v187
v_add_u32 v195, 111616, v188
v_add_u32 v196, 115712, v189
v_add_u32 v197, 115712, v190
s_waitcnt lgkmcnt(0)
s_cmp_eq_u32 s101, 1
s_cbranch_scc1 L_s_nogate
s_mov_b32 s60, s12
s_mov_b32 s61, s13
s_mov_b32 s62, 0x800
s_mov_b32 s63, 0x20000
buffer_load_dwordx4 v[232:235], v10, s[60:63], 0 offen
buffer_load_dwordx4 v[236:239], v10, s[60:63], 0 offen offset:16
L_s_nogate:
s_mov_b32 s36, s4
s_mov_b32 s37, s5
s_mov_b32 s38, 0x400000
s_mov_b32 s39, 0x20000
s_mov_b32 s40, s6
s_mov_b32 s41, s7
s_mov_b32 s42, 0x700000
s_mov_b32 s43, 0x20000
s_add_u32 m0, s91, s87
s_nop 0
buffer_load_dwordx4 v176, s[36:39], s89 offen offset:0 lds
buffer_load_dwordx4 v177, s[36:39], s89 offen offset:1024 lds
buffer_load_dwordx4 v178, s[36:39], s89 offen offset:2048 lds
buffer_load_dwordx4 v179, s[36:39], s89 offen offset:3072 lds
s_add_u32 m0, m0, 4096
s_nop 0
buffer_load_dwordx4 v180, s[36:39], s89 offen offset:0 lds
buffer_load_dwordx4 v181, s[36:39], s89 offen offset:1024 lds
buffer_load_dwordx4 v182, s[36:39], s89 offen offset:2048 lds
buffer_load_dwordx4 v183, s[36:39], s89 offen offset:3072 lds
s_add_u32 m0, s91, s88
s_nop 0
buffer_load_dwordx4 v184, s[40:43], s90 offen offset:0 lds
buffer_load_dwordx4 v185, s[40:43], s90 offen offset:1024 lds
buffer_load_dwordx4 v186, s[40:43], s90 offen offset:2048 lds
buffer_load_dwordx4 v187, s[40:43], s90 offen offset:3072 lds
s_add_u32 m0, m0, 4096
s_nop 0
buffer_load_dwordx4 v188, s[40:43], s90 offen offset:0 lds
buffer_load_dwordx4 v189, s[40:43], s90 offen offset:1024 lds
buffer_load_dwordx4 v190, s[40:43], s90 offen offset:2048 lds
buffer_load_dwordx4 v191, s[40:43], s90 offen offset:3072 lds
s_add_u32 m0, m0, 4096
s_nop 0
buffer_load_dwordx4 v192, s[40:43], s90 offen offset:0 lds
buffer_load_dwordx4 v193, s[40:43], s90 offen offset:1024 lds
buffer_load_dwordx4 v194, s[40:43], s90 offen offset:2048 lds
buffer_load_dwordx4 v195, s[40:43], s90 offen offset:3072 lds
s_add_u32 m0, m0, 4096
s_nop 0
buffer_load_dwordx4 v196, s[40:43], s90 offen offset:0 lds
buffer_load_dwordx4 v197, s[40:43], s90 offen offset:1024 lds
s_add_u32 s89, s89, 128
s_add_u32 s90, s90, 458752
s_add_u32 s91, s91, 45056
s_cmp_eq_u32 s91, 135168
s_cselect_b32 s91, 0, s91
s_add_u32 m0, s91, s87
s_nop 0
buffer_load_dwordx4 v176, s[36:39], s89 offen offset:0 lds
buffer_load_dwordx4 v177, s[36:39], s89 offen offset:1024 lds
buffer_load_dwordx4 v178, s[36:39], s89 offen offset:2048 lds
buffer_load_dwordx4 v179, s[36:39], s89 offen offset:3072 lds
s_add_u32 m0, m0, 4096
s_nop 0
buffer_load_dwordx4 v180, s[36:39], s89 offen offset:0 lds
buffer_load_dwordx4 v181, s[36:39], s89 offen offset:1024 lds
buffer_load_dwordx4 v182, s[36:39], s89 offen offset:2048 lds
buffer_load_dwordx4 v183, s[36:39], s89 offen offset:3072 lds
s_add_u32 m0, s91, s88
s_nop 0
buffer_load_dwordx4 v184, s[40:43], s90 offen offset:0 lds
buffer_load_dwordx4 v185, s[40:43], s90 offen offset:1024 lds
buffer_load_dwordx4 v186, s[40:43], s90 offen offset:2048 lds
buffer_load_dwordx4 v187, s[40:43], s90 offen offset:3072 lds
s_add_u32 m0, m0, 4096
s_nop 0
buffer_load_dwordx4 v188, s[40:43], s90 offen offset:0 lds
buffer_load_dwordx4 v189, s[40:43], s90 offen offset:1024 lds
buffer_load_dwordx4 v190, s[40:43], s90 offen offset:2048 lds
buffer_load_dwordx4 v191, s[40:43], s90 offen offset:3072 lds
s_add_u32 m0, m0, 4096
s_nop 0
buffer_load_dwordx4 v192, s[40:43], s90 offen offset:0 lds
buffer_load_dwordx4 v193, s[40:43], s90 offen offset:1024 lds
buffer_load_dwordx4 v194, s[40:43], s90 offen offset:2048 lds
buffer_load_dwordx4 v195, s[40:43], s90 offen offset:3072 lds
s_add_u32 m0, m0, 4096
s_nop 0
buffer_load_dwordx4 v196, s[40:43], s90 offen offset:0 lds
buffer_load_dwordx4 v197, s[40:43], s90 offen offset:1024 lds
s_add_u32 s89, s89, 128
s_add_u32 s90, s90, 458752
s_add_u32 s91, s91, 45056
s_cmp_eq_u32 s91, 135168
s_cselect_b32 s91, 0, s91
s_cmp_eq_u32 s101, 0
s_cbranch_scc1 L_fft
s_waitcnt vmcnt(40)
s_add_u32 m0, s91, s87
s_nop 0
buffer_load_dwordx4 v176, s[36:39], s89 offen offset:0 lds
buffer_load_dwordx4 v177, s[36:39], s89 offen offset:1024 lds
buffer_load_dwordx4 v178, s[36:39], s89 offen offset:2048 lds
buffer_load_dwordx4 v179, s[36:39], s89 offen offset:3072 lds
s_add_u32 m0, m0, 4096
s_nop 0
buffer_load_dwordx4 v180, s[36:39], s89 offen offset:0 lds
buffer_load_dwordx4 v181, s[36:39], s89 offen offset:1024 lds
buffer_load_dwordx4 v182, s[36:39], s89 offen offset:2048 lds
buffer_load_dwordx4 v183, s[36:39], s89 offen offset:3072 lds
s_add_u32 m0, s91, s88
s_nop 0
buffer_load_dwordx4 v184, s[40:43], s90 offen offset:0 lds
buffer_load_dwordx4 v185, s[40:43], s90 offen offset:1024 lds
buffer_load_dwordx4 v186, s[40:43], s90 offen offset:2048 lds
buffer_load_dwordx4 v187, s[40:43], s90 offen offset:3072 lds
s_add_u32 m0, m0, 4096
s_nop 0
buffer_load_dwordx4 v188, s[40:43], s90 offen offset:0 lds
buffer_load_dwordx4 v189, s[40:43], s90 offen offset:1024 lds
buffer_load_dwordx4 v190, s[40:43], s90 offen offset:2048 lds
buffer_load_dwordx4 v191, s[40:43], s90 offen offset:3072 lds
s_add_u32 m0, m0, 4096
s_nop 0
buffer_load_dwordx4 v192, s[40:43], s90 offen offset:0 lds
buffer_load_dwordx4 v193, s[40:43], s90 offen offset:1024 lds
buffer_load_dwordx4 v194, s[40:43], s90 offen offset:2048 lds
buffer_load_dwordx4 v195, s[40:43], s90 offen offset:3072 lds
s_add_u32 m0, m0, 4096
s_nop 0
buffer_load_dwordx4 v196, s[40:43], s90 offen offset:0 lds
buffer_load_dwordx4 v197, s[40:43], s90 offen offset:1024 lds
s_add_u32 s89, s89, 128
s_add_u32 s90, s90, 458752
s_add_u32 s91, s91, 45056
s_cmp_eq_u32 s91, 135168
s_cselect_b32 s91, 0, s91
s_waitcnt vmcnt(44)
s_barrier
s_mov_b32 s92, 0
s_branch L_g1lloop
L_cstart:
s_mov_b32 s3, 0
s_lshr_b32 s26, s25, 1
s_and_b32 s27, s25, 1
v_lshrrev_b32 v5, 1, v3
v_xor_b32 v5, v5, v4
v_lshlrev_b32 v5, 4, v5
v_lshlrev_b32 v6, 7, v3
v_add_u32 v5, v5, v6
s_lshl_b32 s34, s26, 13
v_add_u32 v240, s34, v5
v_xor_b32 v241, 64, v240
v_lshlrev_b32 v5, 3, v4
v_lshrrev_b32 v6, 2, v3
v_add_u32 v5, v5, v6
v_mul_u32_u24 v5, 448, v5
v_and_b32 v6, 3, v3
v_lshlrev_b32 v6, 3, v6
v_add_u32 v5, v5, v6
v_and_b32 v6, 1, v4
v_lshlrev_b32 v6, 5, v6
s_mul_i32 s35, s27, 224
s_add_u32 s35, s35, 16384
v_add_u32 v5, s35, v5
v_add_u32 v7, v5, v6
v_sub_u32 v8, v5, v6
s_cmp_eq_u32 s27, 0
s_cselect_b64 vcc, -1, 0
s_waitcnt lgkmcnt(0)
v_cndmask_b32 v242, v8, v7, vcc
v_cndmask_b32 v243, v7, v8, vcc
s_add_u32 s52, s8, 0x2000000
s_addc_u32 s53, s9, 0
s_mov_b32 s54, 0x400000
s_mov_b32 s55, 0x20000
s_mov_b32 s76, s98
s_mov_b32 s77, s99
s_mov_b32 s78, 0x100
s_mov_b32 s79, 0x20000
s_mov_b32 s80, s96
s_mov_b32 s81, s97
s_mov_b32 s82, 0x400000
s_mov_b32 s83, 0x20000
s_add_u32 s44, s8, 0x10000
s_addc_u32 s45, s9, 0
s_mov_b32 s46, 0xe00000
s_mov_b32 s47, 0x20000
s_add_u32 s72, s8, 0x1900000
s_addc_u32 s73, s9, 0
s_mov_b32 s74, 0x2000
s_mov_b32 s75, 0x20000
s_add_u32 s56, s8, 0x1800000
s_addc_u32 s57, s9, 0
s_mov_b32 s58, 0x2000
s_mov_b32 s59, 0x20000
s_cmp_eq_u32 s101, 0
s_cbranch_scc1 L_c_late
v_mov_b32 v128, 0
v_mov_b32 v129, 0
v_mov_b32 v130, 0
v_mov_b32 v131, 0
v_mov_b32 v132, 0
v_mov_b32 v133, 0
v_mov_b32 v134, 0
v_mov_b32 v135, 0
v_mov_b32 v136, 0
v_mov_b32 v137, 0
v_mov_b32 v138, 0
v_mov_b32 v139, 0
v_mov_b32 v140, 0
v_mov_b32 v141, 0
v_mov_b32 v142, 0
v_mov_b32 v143, 0
v_mov_b32 v144, 0
v_mov_b32 v145, 0
v_mov_b32 v146, 0
v_mov_b32 v147, 0
v_mov_b32 v148, 0
v_mov_b32 v149, 0
v_mov_b32 v150, 0
v_mov_b32 v151, 0
v_mov_b32 v152, 0
v_mov_b32 v153, 0
v_mov_b32 v154, 0
v_mov_b32 v155, 0
v_mov_b32 v156, 0
v_mov_b32 v157, 0
v_mov_b32 v158, 0
v_mov_b32 v159, 0
v_mov_b32 v160, 0
v_mov_b32 v161, 0
v_mov_b32 v162, 0
v_mov_b32 v163, 0
v_mov_b32 v164, 0
v_mov_b32 v165, 0
v_mov_b32 v166, 0
v_mov_b32 v167, 0
v_mov_b32 v168, 0
v_mov_b32 v169, 0
v_mov_b32 v170, 0
v_mov_b32 v171, 0
v_mov_b32 v172, 0
v_mov_b32 v173, 0
v_mov_b32 v174, 0
v_mov_b32 v175, 0
v_mov_b32 v176, 0
v_mov_b32 v177, 0
v_mov_b32 v178, 0
v_mov_b32 v179, 0
v_mov_b32 v180, 0
v_mov_b32 v181, 0
v_mov_b32 v182, 0
v_mov_b32 v183, 0
v_mov_b32 v184, 0
v_mov_b32 v185, 0
v_mov_b32 v186, 0
v_mov_b32 v187, 0
v_mov_b32 v188, 0
v_mov_b32 v189, 0
v_mov_b32 v190, 0
v_mov_b32 v191, 0
v_mov_b32 v192, 0
v_mov_b32 v193, 0
v_mov_b32 v194, 0
v_mov_b32 v195, 0
v_mov_b32 v196, 0
v_mov_b32 v197, 0
v_mov_b32 v198, 0
v_mov_b32 v199, 0
v_mov_b32 v200, 0
v_mov_b32 v201, 0
v_mov_b32 v202, 0
v_mov_b32 v203, 0
v_mov_b32 v204, 0
v_mov_b32 v205, 0
v_mov_b32 v206, 0
v_mov_b32 v207, 0
v_mov_b32 v208, 0
v_mov_b32 v209, 0
v_mov_b32 v210, 0
v_mov_b32 v211, 0
v_mov_b32 v212, 0
v_mov_b32 v213, 0
v_mov_b32 v214, 0
v_mov_b32 v215, 0
v_mov_b32 v216, 0
v_mov_b32 v217, 0
v_mov_b32 v218, 0
v_mov_b32 v219, 0
v_mov_b32 v220, 0
v_mov_b32 v221, 0
v_mov_b32 v222, 0
v_mov_b32 v223, 0
v_mov_b32 v224, 0
v_mov_b32 v225, 0
v_mov_b32 v226, 0
v_mov_b32 v227, 0
v_mov_b32 v228, 0
v_mov_b32 v229, 0
v_mov_b32 v230, 0
v_mov_b32 v231, 0
v_mov_b32 v232, 0
v_mov_b32 v233, 0
v_mov_b32 v234, 0
v_mov_b32 v235, 0
v_mov_b32 v236, 0
v_mov_b32 v237, 0
v_mov_b32 v238, 0
v_mov_b32 v239, 0
s_branch L_g1c
L_c_late:
s_mov_b32 s60, s12
s_mov_b32 s61, s13
s_mov_b32 s62, 0x800
s_mov_b32 s63, 0x20000
buffer_load_dwordx4 v[232:235], v10, s[60:63], 0 offen
buffer_load_dwordx4 v[236:239], v10, s[60:63], 0 offen offset:16
L_fft:
s_add_u32 s48, s8, 0x1000000
s_addc_u32 s49, s9, 0
s_mov_b32 s50, 0x800000
s_mov_b32 s51, 0x20000
s_add_u32 s56, s8, 0x1800000
s_addc_u32 s57, s9, 0
s_mov_b32 s58, 0x2000
s_mov_b32 s59, 0x20000
v_cvt_f32_u32 v5, v3
v_cvt_f32_u32 v6, v4
s_lshl_b32 s30, s29, 4
v_add_u32 v7, s30, v3
v_cvt_f32_u32 v7, v7
v_mul_f32 v8, 0x3d000000, v7
v_mul_f32 v9, 0x41000000, v6
v_mul_f32 v9, v9, v8
v_cos_f32 v72, v9
v_sin_f32 v80, -v9
v_add_f32 v9, v9, v8
v_cos_f32 v73, v9
v_sin_f32 v81, -v9
v_add_f32 v9, v9, v8
v_cos_f32 v74, v9
v_sin_f32 v82, -v9
v_add_f32 v9, v9, v8
v_cos_f32 v75, v9
v_sin_f32 v83, -v9
v_add_f32 v9, v9, v8
v_cos_f32 v76, v9
v_sin_f32 v84, -v9
v_add_f32 v9, v9, v8
v_cos_f32 v77, v9
v_sin_f32 v85, -v9
v_add_f32 v9, v9, v8
v_cos_f32 v78, v9
v_sin_f32 v86, -v9
v_add_f32 v9, v9, v8
v_cos_f32 v79, v9
v_sin_f32 v87, -v9
v_cvt_pk_bf16_f32 v16, v72, v73
v_cvt_pk_bf16_f32 v20, v80, v81
v_cvt_pk_bf16_f32 v17, v74, v75
v_cvt_pk_bf16_f32 v21, v82, v83
v_cvt_pk_bf16_f32 v18, v76, v77
v_cvt_pk_bf16_f32 v22, v84, v85
v_cvt_pk_bf16_f32 v19, v78, v79
v_cvt_pk_bf16_f32 v23, v86, v87
v_mul_f32 v8, 0x3a800000, v7
v_mul_f32 v9, 4.0, v6
v_mul_f32 v9, v9, v8
v_mul_f32 v10, 0x41500000, v8
v_cos_f32 v24, v9
v_sin_f32 v32, v9
v_add_f32 v9, v9, v8
v_cos_f32 v25, v9
v_sin_f32 v33, v9
v_add_f32 v9, v9, v8
v_cos_f32 v26, v9
v_sin_f32 v34, v9
v_add_f32 v9, v9, v8
v_cos_f32 v27, v9
v_sin_f32 v35, v9
v_add_f32 v9, v9, v10
v_cos_f32 v28, v9
v_sin_f32 v36, v9
v_add_f32 v9, v9, v8
v_cos_f32 v29, v9
v_sin_f32 v37, v9
v_add_f32 v9, v9, v8
v_cos_f32 v30, v9
v_sin_f32 v38, v9
v_add_f32 v9, v9, v8
v_cos_f32 v31, v9
v_sin_f32 v39, v9
v_add_f32 v8, 0, v5
v_mul_f32 v8, 0x3d000000, v8
v_mul_f32 v9, 4.0, v6
v_mul_f32 v9, v9, v8
v_mul_f32 v10, 0x41500000, v8
v_cos_f32 v72, v9
v_sin_f32 v80, v9
v_add_f32 v9, v9, v8
v_cos_f32 v73, v9
v_sin_f32 v81, v9
v_add_f32 v9, v9, v8
v_cos_f32 v74, v9
v_sin_f32 v82, v9
v_add_f32 v9, v9, v8
v_cos_f32 v75, v9
v_sin_f32 v83, v9
v_add_f32 v9, v9, v10
v_cos_f32 v76, v9
v_sin_f32 v84, v9
v_add_f32 v9, v9, v8
v_cos_f32 v77, v9
v_sin_f32 v85, v9
v_add_f32 v9, v9, v8
v_cos_f32 v78, v9
v_sin_f32 v86, v9
v_add_f32 v9, v9, v8
v_cos_f32 v79, v9
v_sin_f32 v87, v9
v_cvt_pk_bf16_f32 v40, v72, v73
v_cvt_pk_bf16_f32 v48, v80, v81
v_cvt_pk_bf16_f32 v41, v74, v75
v_cvt_pk_bf16_f32 v49, v82, v83
v_cvt_pk_bf16_f32 v42, v76, v77
v_cvt_pk_bf16_f32 v50, v84, v85
v_cvt_pk_bf16_f32 v43, v78, v79
v_cvt_pk_bf16_f32 v51, v86, v87
v_xor_b32 v56, 0x80008000, v48
v_xor_b32 v57, 0x80008000, v49
v_xor_b32 v58, 0x80008000, v50
v_xor_b32 v59, 0x80008000, v51
v_add_f32 v8, 0x41800000, v5
v_mul_f32 v8, 0x3d000000, v8
v_mul_f32 v9, 4.0, v6
v_mul_f32 v9, v9, v8
v_mul_f32 v10, 0x41500000, v8
v_cos_f32 v72, v9
v_sin_f32 v80, v9
v_add_f32 v9, v9, v8
v_cos_f32 v73, v9
v_sin_f32 v81, v9
v_add_f32 v9, v9, v8
v_cos_f32 v74, v9
v_sin_f32 v82, v9
v_add_f32 v9, v9, v8
v_cos_f32 v75, v9
v_sin_f32 v83, v9
v_add_f32 v9, v9, v10
v_cos_f32 v76, v9
v_sin_f32 v84, v9
v_add_f32 v9, v9, v8
v_cos_f32 v77, v9
v_sin_f32 v85, v9
v_add_f32 v9, v9, v8
v_cos_f32 v78, v9
v_sin_f32 v86, v9
v_add_f32 v9, v9, v8
v_cos_f32 v79, v9
v_sin_f32 v87, v9
v_cvt_pk_bf16_f32 v44, v72, v73
v_cvt_pk_bf16_f32 v52, v80, v81
v_cvt_pk_bf16_f32 v45, v74, v75
v_cvt_pk_bf16_f32 v53, v82, v83
v_cvt_pk_bf16_f32 v46, v76, v77
v_cvt_pk_bf16_f32 v54, v84, v85
v_cvt_pk_bf16_f32 v47, v78, v79
v_cvt_pk_bf16_f32 v55, v86, v87
v_xor_b32 v60, 0x80008000, v52
v_xor_b32 v61, 0x80008000, v53
v_xor_b32 v62, 0x80008000, v54
v_xor_b32 v63, 0x80008000, v55
v_and_b32 v8, 1, v4
v_lshlrev_b32 v8, 10, v8
v_add_u32 v8, s28, v8
v_mul_u32_u24 v8, v8, v3
v_cvt_f32_u32 v8, v8
v_mul_f32 v9, 0x3a000000, v8
v_lshrrev_b32 v8, 1, v4
v_cvt_f32_u32 v8, v8
v_mul_f32 v8, 0x3e800000, v8
v_sub_f32 v9, v9, v8
v_mul_f32 v8, 0x3d800000, v5
v_cos_f32 v72, v9
v_sin_f32 v80, v9
v_add_f32 v9, v9, v8
v_cos_f32 v73, v9
v_sin_f32 v81, v9
v_add_f32 v9, v9, v8
v_cos_f32 v74, v9
v_sin_f32 v82, v9
v_add_f32 v9, v9, v8
v_cos_f32 v75, v9
v_sin_f32 v83, v9
v_add_f32 v9, v9, v8
v_cos_f32 v76, v9
v_sin_f32 v84, v9
v_add_f32 v9, v9, v8
v_cos_f32 v77, v9
v_sin_f32 v85, v9
v_add_f32 v9, v9, v8
v_cos_f32 v78, v9
v_sin_f32 v86, v9
v_add_f32 v9, v9, v8
v_cos_f32 v79, v9
v_sin_f32 v87, v9
v_cvt_pk_bf16_f32 v64, v72, v73
v_cvt_pk_bf16_f32 v68, v80, v81
v_cvt_pk_bf16_f32 v65, v74, v75
v_cvt_pk_bf16_f32 v69, v82, v83
v_cvt_pk_bf16_f32 v66, v76, v77
v_cvt_pk_bf16_f32 v70, v84, v85
v_cvt_pk_bf16_f32 v67, v78, v79
v_cvt_pk_bf16_f32 v71, v86, v87
v_lshlrev_b32 v5, 3, v4
v_lshrrev_b32 v6, 2, v3
v_add_u32 v5, v5, v6
v_lshlrev_b32 v5, 6, v5
v_and_b32 v6, 3, v3
v_lshl_add_u32 v5, v6, 3, v5
v_and_b32 v6, 1, v4
v_lshl_add_u32 v5, v6, 5, v5
s_lshl_b32 s30, s25, 12
s_add_u32 s30, s30, 131072
v_add_u32 v10, s30, v5
v_xor_b32 v11, 32, v10
s_lshl_b32 s31, s29, 11
s_add_u32 s31, s31, s30
v_lshlrev_b32 v5, 5, v1
v_add_u32 v15, s31, v5
s_lshl_b32 s31, s25, 1
s_add_u32 s31, s31, 0
s_and_b32 s32, s31, 3
s_lshr_b32 s33, s31, 3
s_lshl_b32 s33, s33, 2
s_or_b32 s32, s32, s33
v_xor_b32 v5, s32, v3
v_lshlrev_b32 v5, 5, v5
v_lshl_add_u32 v5, v4, 3, v5
s_add_u32 s33, s30, 0
v_add_u32 v12, s33, v5
s_lshl_b32 s31, s25, 1
s_add_u32 s31, s31, 1
s_and_b32 s32, s31, 3
s_lshr_b32 s33, s31, 3
s_lshl_b32 s33, s33, 2
s_or_b32 s32, s32, s33
v_xor_b32 v5, s32, v3
v_lshlrev_b32 v5, 5, v5
v_lshl_add_u32 v5, v4, 3, v5
s_add_u32 s33, s30, 2048
v_add_u32 v13, s33, v5
v_and_b32 v5, 1, v4
v_lshlrev_b32 v6, 3, v5
v_lshrrev_b32 v7, 2, v3
v_add_u32 v6, v6, v7
v_lshlrev_b32 v6, 11, v6
v_lshrrev_b32 v8, 1, v4
v_lshl_add_u32 v6, v8, 10, v6
v_lshlrev_b32 v5, 2, v5
v_or_b32 v5, v5, v7
s_lshl_b32 s31, s25, 2
v_xor_b32 v5, s31, v5
v_lshl_add_u32 v6, v5, 5, v6
v_and_b32 v5, 3, v3
v_lshl_add_u32 v6, v5, 3, v6
v_add_u32 v14, 131072, v6
v_lshlrev_b32 v132, 6, v3
v_and_b32 v5, 1, v4
v_lshl_add_u32 v132, v5, 5, v132
v_lshrrev_b32 v5, 1, v4
v_lshl_add_u32 v132, v5, 4, v132
s_cmp_eq_u32 s101, 1
s_cbranch_scc1 L_nozero
s_cmp_eq_u32 s3, 0
s_cbranch_scc0 L_nozero
v_mov_b32 v136, 0
v_mov_b32 v137, 0
v_mov_b32 v138, 0
v_mov_b32 v139, 0
v_mov_b32 v140, 0
v_mov_b32 v141, 0
v_mov_b32 v142, 0
v_mov_b32 v143, 0
v_mov_b32 v144, 0
v_mov_b32 v145, 0
v_mov_b32 v146, 0
v_mov_b32 v147, 0
v_mov_b32 v148, 0
v_mov_b32 v149, 0
v_mov_b32 v150, 0
v_mov_b32 v151, 0
v_mov_b32 v152, 0
v_mov_b32 v153, 0
v_mov_b32 v154, 0
v_mov_b32 v155, 0
v_mov_b32 v156, 0
v_mov_b32 v157, 0
v_mov_b32 v158, 0
v_mov_b32 v159, 0
v_mov_b32 v160, 0
v_mov_b32 v161, 0
v_mov_b32 v162, 0
v_mov_b32 v163, 0
v_mov_b32 v164, 0
v_mov_b32 v165, 0
v_mov_b32 v166, 0
v_mov_b32 v167, 0
v_mov_b32 v168, 0
v_mov_b32 v169, 0
v_mov_b32 v170, 0
v_mov_b32 v171, 0
v_mov_b32 v172, 0
v_mov_b32 v173, 0
v_mov_b32 v174, 0
v_mov_b32 v175, 0
v_mov_b32 v176, 0
v_mov_b32 v177, 0
v_mov_b32 v178, 0
v_mov_b32 v179, 0
v_mov_b32 v180, 0
v_mov_b32 v181, 0
v_mov_b32 v182, 0
v_mov_b32 v183, 0
v_mov_b32 v184, 0
v_mov_b32 v185, 0
v_mov_b32 v186, 0
v_mov_b32 v187, 0
v_mov_b32 v188, 0
v_mov_b32 v189, 0
v_mov_b32 v190, 0
v_mov_b32 v191, 0
v_mov_b32 v192, 0
v_mov_b32 v193, 0
v_mov_b32 v194, 0
v_mov_b32 v195, 0
v_mov_b32 v196, 0
v_mov_b32 v197, 0
v_mov_b32 v198, 0
v_mov_b32 v199, 0
v_mov_b32 v200, 0
v_mov_b32 v201, 0
v_mov_b32 v202, 0
v_mov_b32 v203, 0
v_mov_b32 v204, 0
v_mov_b32 v205, 0
v_mov_b32 v206, 0
v_mov_b32 v207, 0
v_mov_b32 v208, 0
v_mov_b32 v209, 0
v_mov_b32 v210, 0
v_mov_b32 v211, 0
v_mov_b32 v212, 0
v_mov_b32 v213, 0
v_mov_b32 v214, 0
v_mov_b32 v215, 0
v_mov_b32 v216, 0
v_mov_b32 v217, 0
v_mov_b32 v218, 0
v_mov_b32 v219, 0
v_mov_b32 v220, 0
v_mov_b32 v221, 0
v_mov_b32 v222, 0
v_mov_b32 v223, 0
v_mov_b32 v224, 0
v_mov_b32 v225, 0
v_mov_b32 v226, 0
v_mov_b32 v227, 0
v_mov_b32 v228, 0
v_mov_b32 v229, 0
v_mov_b32 v230, 0
v_mov_b32 v231, 0
L_nozero:
s_cmp_eq_u32 s101, 1
s_cbranch_scc1 L_b1c
s_cmp_eq_u32 s3, 0
s_cbranch_scc1 L_b1c
s_cmp_eq_u32 s3, 1
s_cbranch_scc1 L_b1s
s_waitcnt vmcnt(0)
s_branch L_b1
L_b1s:
s_waitcnt vmcnt(44)
s_branch L_b1
L_b1c:
s_waitcnt vmcnt(0)
L_b1:
s_barrier
s_cmp_eq_u32 s101, 1
s_cbranch_scc1 L_hkb1
s_cmp_eq_u32 s3, 2
s_cbranch_scc0 L_h2b1
s_sub_u32 s35, s95, 2
s_lshl_b32 s31, s2, 14
s_lshl_b32 s32, s35, 13
s_add_u32 s31, s31, s32
buffer_load_dwordx4 v[244:247], v200, s[36:39], s31 offen offset:0
buffer_load_dwordx4 v[244:247], v200, s[36:39], s31 offen offset:1024
buffer_load_dwordx4 v[244:247], v200, s[36:39], s31 offen offset:2048
buffer_load_dwordx4 v[244:247], v200, s[36:39], s31 offen offset:3072
s_add_u32 s31, s31, 4096
buffer_load_dwordx4 v[244:247], v200, s[36:39], s31 offen offset:0
buffer_load_dwordx4 v[244:247], v200, s[36:39], s31 offen offset:1024
buffer_load_dwordx4 v[244:247], v200, s[36:39], s31 offen offset:2048
buffer_load_dwordx4 v[244:247], v200, s[36:39], s31 offen offset:3072
s_mul_i32 s31, s2, 28672
s_mul_i32 s32, s35, 14336
s_add_u32 s31, s31, s32
buffer_load_dwordx4 v[244:247], v200, s[40:43], s31 offen offset:0
buffer_load_dwordx4 v[244:247], v200, s[40:43], s31 offen offset:1024
buffer_load_dwordx4 v[244:247], v200, s[40:43], s31 offen offset:2048
buffer_load_dwordx4 v[244:247], v200, s[40:43], s31 offen offset:3072
s_add_u32 s31, s31, 4096
buffer_load_dwordx4 v[244:247], v200, s[40:43], s31 offen offset:0
buffer_load_dwordx4 v[244:247], v200, s[40:43], s31 offen offset:1024
buffer_load_dwordx4 v[244:247], v200, s[40:43], s31 offen offset:2048
buffer_load_dwordx4 v[244:247], v200, s[40:43], s31 offen offset:3072
s_add_u32 s31, s31, 4096
buffer_load_dwordx4 v[244:247], v200, s[40:43], s31 offen offset:0
buffer_load_dwordx4 v[244:247], v200, s[40:43], s31 offen offset:1024
buffer_load_dwordx4 v[244:247], v200, s[40:43], s31 offen offset:2048
buffer_load_dwordx4 v[244:247], v200, s[40:43], s31 offen offset:3072
s_add_u32 s31, s31, 4096
buffer_load_dwordx4 v[244:247], v200, s[40:43], s31 offen offset:0
buffer_load_dwordx4 v[244:247], v200, s[40:43], s31 offen offset:1024
L_h2b1:
L_hkb1:
ds_read_b64_tr_b16 v[72:73], v10 offset:0
ds_read_b64_tr_b16 v[74:75], v10 offset:256
ds_read_b64_tr_b16 v[76:77], v11 offset:0
ds_read_b64_tr_b16 v[78:79], v11 offset:256
ds_read_b64_tr_b16 v[80:81], v10 offset:2048
ds_read_b64_tr_b16 v[82:83], v10 offset:2304
ds_read_b64_tr_b16 v[84:85], v11 offset:2048
ds_read_b64_tr_b16 v[86:87], v11 offset:2304
ds_read_b128 v[120:123], v15
ds_read_b128 v[124:127], v15 offset:16
s_waitcnt lgkmcnt(6)
v_mfma_f32_16x16x32_bf16 v[88:91], v[72:75], v[16:19], 0
v_mfma_f32_16x16x32_bf16 v[92:95], v[72:75], v[20:23], 0
v_mfma_f32_16x16x32_bf16 v[96:99], v[76:79], v[16:19], 0
v_mfma_f32_16x16x32_bf16 v[100:103], v[76:79], v[20:23], 0
s_waitcnt lgkmcnt(2)
v_mfma_f32_16x16x32_bf16 v[104:107], v[80:83], v[16:19], 0
v_mfma_f32_16x16x32_bf16 v[108:111], v[80:83], v[20:23], 0
v_mfma_f32_16x16x32_bf16 v[112:115], v[84:87], v[16:19], 0
v_mfma_f32_16x16x32_bf16 v[116:119], v[84:87], v[20:23], 0
s_waitcnt lgkmcnt(0)
v_mov_b32 v5, 0
v_dot2_f32_bf16 v5, v120, v232, v5
v_dot2_f32_bf16 v5, v121, v233, v5
v_dot2_f32_bf16 v5, v122, v234, v5
v_dot2_f32_bf16 v5, v123, v235, v5
v_dot2_f32_bf16 v5, v124, v236, v5
v_dot2_f32_bf16 v5, v125, v237, v5
v_dot2_f32_bf16 v5, v126, v238, v5
v_dot2_f32_bf16 v5, v127, v239, v5
v_pk_mul_f32 v[6:7], v[88:89], v[24:25]
v_pk_mul_f32 v[8:9], v[92:93], v[24:25]
v_pk_fma_f32 v[92:93], v[92:93], v[32:33], v[6:7]
v_pk_fma_f32 v[88:89], v[88:89], v[32:33], v[8:9] neg_lo:[1,0,0] neg_hi:[1,0,0]
v_pk_mul_f32 v[128:129], v[90:91], v[26:27]
v_pk_mul_f32 v[130:131], v[94:95], v[26:27]
v_pk_fma_f32 v[94:95], v[94:95], v[34:35], v[128:129]
v_pk_fma_f32 v[90:91], v[90:91], v[34:35], v[130:131] neg_lo:[1,0,0] neg_hi:[1,0,0]
v_pk_mul_f32 v[6:7], v[96:97], v[28:29]
v_pk_mul_f32 v[8:9], v[100:101], v[28:29]
v_pk_fma_f32 v[100:101], v[100:101], v[36:37], v[6:7]
v_pk_fma_f32 v[96:97], v[96:97], v[36:37], v[8:9] neg_lo:[1,0,0] neg_hi:[1,0,0]
v_pk_mul_f32 v[128:129], v[98:99], v[30:31]
v_pk_mul_f32 v[130:131], v[102:103], v[30:31]
v_pk_fma_f32 v[102:103], v[102:103], v[38:39], v[128:129]
v_pk_fma_f32 v[98:99], v[98:99], v[38:39], v[130:131] neg_lo:[1,0,0] neg_hi:[1,0,0]
v_cvt_pk_bf16_f32 v72, v92, v93
v_cvt_pk_bf16_f32 v73, v94, v95
v_cvt_pk_bf16_f32 v76, v88, v89
v_cvt_pk_bf16_f32 v77, v90, v91
v_cvt_pk_bf16_f32 v74, v100, v101
v_cvt_pk_bf16_f32 v75, v102, v103
v_cvt_pk_bf16_f32 v78, v96, v97
v_cvt_pk_bf16_f32 v79, v98, v99
v_mfma_f32_16x16x32_bf16 v[88:91], v[72:75], v[40:43], 0
v_pk_mul_f32 v[6:7], v[104:105], v[24:25]
v_pk_mul_f32 v[8:9], v[108:109], v[24:25]
v_pk_fma_f32 v[108:109], v[108:109], v[32:33], v[6:7]
v_pk_fma_f32 v[104:105], v[104:105], v[32:33], v[8:9] neg_lo:[1,0,0] neg_hi:[1,0,0]
v_mfma_f32_16x16x32_bf16 v[96:99], v[72:75], v[44:47], 0
v_pk_mul_f32 v[128:129], v[106:107], v[26:27]
v_pk_mul_f32 v[130:131], v[110:111], v[26:27]
v_pk_fma_f32 v[110:111], v[110:111], v[34:35], v[128:129]
v_pk_fma_f32 v[106:107], v[106:107], v[34:35], v[130:131] neg_lo:[1,0,0] neg_hi:[1,0,0]
v_mfma_f32_16x16x32_bf16 v[92:95], v[76:79], v[40:43], 0
v_pk_mul_f32 v[6:7], v[112:113], v[28:29]
v_pk_mul_f32 v[8:9], v[116:117], v[28:29]
v_pk_fma_f32 v[116:117], v[116:117], v[36:37], v[6:7]
v_pk_fma_f32 v[112:113], v[112:113], v[36:37], v[8:9] neg_lo:[1,0,0] neg_hi:[1,0,0]
v_mfma_f32_16x16x32_bf16 v[100:103], v[76:79], v[44:47], 0
v_pk_mul_f32 v[128:129], v[114:115], v[30:31]
v_pk_mul_f32 v[130:131], v[118:119], v[30:31]
v_pk_fma_f32 v[118:119], v[118:119], v[38:39], v[128:129]
v_pk_fma_f32 v[114:115], v[114:115], v[38:39], v[130:131] neg_lo:[1,0,0] neg_hi:[1,0,0]
v_mfma_f32_16x16x32_bf16 v[88:91], v[76:79], v[48:51], v[88:91]
v_cvt_pk_bf16_f32 v80, v108, v109
v_cvt_pk_bf16_f32 v81, v110, v111
v_cvt_pk_bf16_f32 v84, v104, v105
v_cvt_pk_bf16_f32 v85, v106, v107
v_mfma_f32_16x16x32_bf16 v[96:99], v[76:79], v[52:55], v[96:99]
v_cvt_pk_bf16_f32 v82, v116, v117
v_cvt_pk_bf16_f32 v83, v118, v119
v_cvt_pk_bf16_f32 v86, v112, v113
v_cvt_pk_bf16_f32 v87, v114, v115
v_mfma_f32_16x16x32_bf16 v[92:95], v[72:75], v[56:59], v[92:95]
v_mfma_f32_16x16x32_bf16 v[100:103], v[72:75], v[60:63], v[100:103]
s_nop 1
v_mfma_f32_16x16x32_bf16 v[104:107], v[80:83], v[40:43], 0
v_add_f32 v5, v5, v5 row_ror:8 row_mask:0xf bank_mask:0xf
v_mfma_f32_16x16x32_bf16 v[112:115], v[80:83], v[44:47], 0
s_nop 1
v_mfma_f32_16x16x32_bf16 v[108:111], v[84:87], v[40:43], 0
v_add_f32 v5, v5, v5 row_ror:4 row_mask:0xf bank_mask:0xf
v_mfma_f32_16x16x32_bf16 v[116:119], v[84:87], v[44:47], 0
s_nop 1
v_mfma_f32_16x16x32_bf16 v[104:107], v[84:87], v[48:51], v[104:107]
v_add_f32 v5, v5, v5 row_ror:2 row_mask:0xf bank_mask:0xf
v_mfma_f32_16x16x32_bf16 v[112:115], v[84:87], v[52:55], v[112:115]
s_nop 1
v_mfma_f32_16x16x32_bf16 v[108:111], v[80:83], v[56:59], v[108:111]
v_add_f32 v5, v5, v5 row_ror:1 row_mask:0xf bank_mask:0xf
v_mfma_f32_16x16x32_bf16 v[116:119], v[80:83], v[60:63], v[116:119]
s_nop 0
v_readlane_b32 s30, v5, 0
v_readlane_b32 s31, v5, 16
v_readlane_b32 s32, v5, 32
v_readlane_b32 s33, v5, 48
v_mov_b32 v5, s30
v_add_f32 v5, s31, v5
v_add_f32 v5, s32, v5
v_add_f32 v5, s33, v5
v_mul_f32 v5, 0xbfb8aa3b, v5
v_exp_f32 v5, v5
v_cvt_pk_bf16_f32 v72, v88, v89
v_add_f32 v5, 1.0, v5
v_cvt_pk_bf16_f32 v73, v90, v91
v_rcp_f32 v5, v5
ds_write_b64 v12, v[72:73] offset:0
v_cvt_pk_bf16_f32 v74, v92, v93
v_cvt_pk_bf16_f32 v75, v94, v95
ds_write_b64 v12, v[74:75] offset:1024
v_cvt_pk_bf16_f32 v76, v96, v97
v_cvt_pk_bf16_f32 v77, v98, v99
ds_write_b64 v12, v[76:77] offset:512
v_cvt_pk_bf16_f32 v78, v100, v101
v_cvt_pk_bf16_f32 v79, v102, v103
ds_write_b64 v12, v[78:79] offset:1536
s_lshl_b32 s30, s25, 1
s_add_u32 s30, s30, s29
s_lshl_b32 s30, s30, 3
s_lshr_b32 s31, s28, 4
s_add_u32 s30, s30, s31
s_and_b32 s31, s28, 15
s_lshl_b32 s31, s31, 7
s_add_u32 s30, s30, s31
s_lshl_b32 s30, s30, 2
v_mov_b32 v6, 0
s_mov_b64 exec, 1
buffer_store_dword v5, v6, s[56:59], s30 offen sc1
s_mov_b64 exec, -1
v_cvt_pk_bf16_f32 v80, v104, v105
v_cvt_pk_bf16_f32 v81, v106, v107
ds_write_b64 v13, v[80:81] offset:0
v_cvt_pk_bf16_f32 v82, v108, v109
v_cvt_pk_bf16_f32 v83, v110, v111
ds_write_b64 v13, v[82:83] offset:1024
v_cvt_pk_bf16_f32 v84, v112, v113
v_cvt_pk_bf16_f32 v85, v114, v115
ds_write_b64 v13, v[84:85] offset:512
v_cvt_pk_bf16_f32 v86, v116, v117
v_cvt_pk_bf16_f32 v87, v118, v119
ds_write_b64 v13, v[86:87] offset:1536
s_waitcnt lgkmcnt(0)
s_barrier
s_cmp_eq_u32 s101, 1
s_cbranch_scc1 L_hkb2
s_cmp_eq_u32 s3, 1
s_cbranch_scc0 L_h3
s_mov_b32 s96, s90
s_add_u32 s97, s91, s88
s_add_u32 s97, s97, 8192
s_add_u32 m0, s91, s87
s_nop 0
buffer_load_dwordx4 v176, s[36:39], s89 offen offset:0 lds
buffer_load_dwordx4 v177, s[36:39], s89 offen offset:1024 lds
buffer_load_dwordx4 v178, s[36:39], s89 offen offset:2048 lds
buffer_load_dwordx4 v179, s[36:39], s89 offen offset:3072 lds
s_add_u32 m0, m0, 4096
s_nop 0
buffer_load_dwordx4 v180, s[36:39], s89 offen offset:0 lds
buffer_load_dwordx4 v181, s[36:39], s89 offen offset:1024 lds
buffer_load_dwordx4 v182, s[36:39], s89 offen offset:2048 lds
buffer_load_dwordx4 v183, s[36:39], s89 offen offset:3072 lds
s_add_u32 m0, s91, s88
s_nop 0
buffer_load_dwordx4 v184, s[40:43], s90 offen offset:0 lds
buffer_load_dwordx4 v185, s[40:43], s90 offen offset:1024 lds
buffer_load_dwordx4 v186, s[40:43], s90 offen offset:2048 lds
buffer_load_dwordx4 v187, s[40:43], s90 offen offset:3072 lds
s_add_u32 m0, m0, 4096
s_nop 0
buffer_load_dwordx4 v188, s[40:43], s90 offen offset:0 lds
buffer_load_dwordx4 v189, s[40:43], s90 offen offset:1024 lds
buffer_load_dwordx4 v190, s[40:43], s90 offen offset:2048 lds
buffer_load_dwordx4 v191, s[40:43], s90 offen offset:3072 lds
s_add_u32 m0, m0, 4096
s_nop 0
buffer_load_dwordx4 v192, s[40:43], s90 offen offset:0 lds
buffer_load_dwordx4 v193, s[40:43], s90 offen offset:1024 lds
s_cmp_eq_u32 s95, 1
s_cbranch_scc1 L_s2skip
buffer_load_dwordx4 v194, s[40:43], s90 offen offset:2048 lds
buffer_load_dwordx4 v195, s[40:43], s90 offen offset:3072 lds
s_add_u32 m0, m0, 4096
s_nop 0
buffer_load_dwordx4 v196, s[40:43], s90 offen offset:0 lds
buffer_load_dwordx4 v197, s[40:43], s90 offen offset:1024 lds
L_s2skip:
s_add_u32 s89, s89, 128
s_add_u32 s90, s90, 458752
s_add_u32 s91, s91, 45056
s_cmp_eq_u32 s91, 135168
s_cselect_b32 s91, 0, s91
L_h3:
L_hkb2:
v_xor_b32 v6, 32, v14
v_xor_b32 v7, 64, v14
v_xor_b32 v8, 96, v14
ds_read_b64_tr_b16 v[72:73], v14
ds_read_b64_tr_b16 v[74:75], v14 offset:8192
ds_read_b64_tr_b16 v[76:77], v6
ds_read_b64_tr_b16 v[78:79], v6 offset:8192
ds_read_b64_tr_b16 v[80:81], v7
ds_read_b64_tr_b16 v[82:83], v7 offset:8192
ds_read_b64_tr_b16 v[84:85], v8
ds_read_b64_tr_b16 v[86:87], v8 offset:8192
s_lshl_b32 s30, s28, 15
s_lshl_b32 s31, s29, 14
s_add_u32 s30, s30, s31
s_lshl_b32 s31, s25, 11
s_add_u32 s30, s30, s31
s_add_u32 s31, s30, 4194304
s_waitcnt lgkmcnt(0)
s_barrier
v_mfma_f32_16x16x32_bf16 v[88:91], v[72:75], v[64:67], 0
v_mfma_f32_16x16x32_bf16 v[92:95], v[72:75], v[68:71], 0
v_mfma_f32_16x16x32_bf16 v[96:99], v[76:79], v[64:67], 0
v_mfma_f32_16x16x32_bf16 v[100:103], v[76:79], v[68:71], 0
v_mfma_f32_16x16x32_bf16 v[104:107], v[80:83], v[64:67], 0
v_mfma_f32_16x16x32_bf16 v[108:111], v[80:83], v[68:71], 0
v_mfma_f32_16x16x32_bf16 v[112:115], v[84:87], v[64:67], 0
v_mfma_f32_16x16x32_bf16 v[116:119], v[84:87], v[68:71], 0
s_nop 5
v_cvt_pk_bf16_f32 v72, v88, v89
v_cvt_pk_bf16_f32 v73, v90, v91
v_cvt_pk_bf16_f32 v74, v96, v97
v_cvt_pk_bf16_f32 v75, v98, v99
v_cvt_pk_bf16_f32 v76, v104, v105
v_cvt_pk_bf16_f32 v77, v106, v107
v_cvt_pk_bf16_f32 v78, v112, v113
v_cvt_pk_bf16_f32 v79, v114, v115
v_cvt_pk_bf16_f32 v80, v92, v93
v_cvt_pk_bf16_f32 v81, v94, v95
v_cvt_pk_bf16_f32 v82, v100, v101
v_cvt_pk_bf16_f32 v83, v102, v103
v_cvt_pk_bf16_f32 v84, v108, v109
v_cvt_pk_bf16_f32 v85, v110, v111
v_cvt_pk_bf16_f32 v86, v116, v117
v_cvt_pk_bf16_f32 v87, v118, v119
s_nop 1
v_permlane16_swap_b32 v72, v74
v_permlane16_swap_b32 v73, v75
v_permlane16_swap_b32 v76, v78
v_permlane16_swap_b32 v77, v79
v_permlane16_swap_b32 v80, v82
v_permlane16_swap_b32 v81, v83
v_permlane16_swap_b32 v84, v86
v_permlane16_swap_b32 v85, v87
s_nop 1
buffer_store_dwordx4 v[72:75], v132, s[48:51], s30 offen offset:0 sc1
buffer_store_dwordx4 v[76:79], v132, s[48:51], s30 offen offset:1024 sc1
buffer_store_dwordx4 v[80:83], v132, s[48:51], s31 offen offset:0 sc1
buffer_store_dwordx4 v[84:87], v132, s[48:51], s31 offen offset:1024 sc1
s_cmp_eq_u32 s101, 0
s_cbranch_scc1 L_fft_late
s_cmp_eq_u32 s3, 0
s_cbranch_scc1 L_g2setup
s_branch L_lsetup2
L_fft_late:
s_cmp_eq_u32 s3, 2
s_cbranch_scc1 L_help_g1
s_cmp_eq_u32 s3, 1
s_cbranch_scc1 L_stage_g1
L_g1c:
v_mov_b32 v119, v240
v_mov_b32 v120, v241
v_mov_b32 v121, v242
v_mov_b32 v122, v243
s_mov_b32 s93, 0
s_mov_b32 s94, 0
v_mov_b32 v232, 0
v_mov_b32 v233, 0
v_mov_b32 v234, 0
v_mov_b32 v235, 0
v_mov_b32 v236, 0
v_mov_b32 v237, 0
v_mov_b32 v238, 0
v_mov_b32 v239, 0
s_barrier
ds_read_b128 v[16:19], v119 offset:0
ds_read_b64_tr_b16 v[32:33], v121 offset:0
ds_read_b64_tr_b16 v[34:35], v121 offset:1792
ds_read_b128 v[20:23], v119 offset:2048
ds_read_b64_tr_b16 v[36:37], v122 offset:32
ds_read_b64_tr_b16 v[38:39], v122 offset:1824
ds_read_b128 v[24:27], v119 offset:4096
ds_read_b64_tr_b16 v[40:41], v121 offset:64
ds_read_b64_tr_b16 v[42:43], v121 offset:1856
ds_read_b128 v[28:31], v119 offset:6144
ds_read_b64_tr_b16 v[44:45], v122 offset:96
ds_read_b64_tr_b16 v[46:47], v122 offset:1888
ds_read_b64_tr_b16 v[48:49], v121 offset:128
ds_read_b64_tr_b16 v[50:51], v121 offset:1920
ds_read_b64_tr_b16 v[52:53], v122 offset:160
ds_read_b64_tr_b16 v[54:55], v122 offset:1952
ds_read_b64_tr_b16 v[56:57], v121 offset:192
ds_read_b64_tr_b16 v[58:59], v121 offset:1984
v_mov_b32 v128, 0
v_mov_b32 v129, 0
v_mov_b32 v130, 0
v_mov_b32 v131, 0
v_mov_b32 v132, 0
v_mov_b32 v133, 0
v_mov_b32 v134, 0
v_mov_b32 v135, 0
s_waitcnt lgkmcnt(0)
.p2align 6
L_g1loop:
v_mfma_f32_16x16x32_bf16 v[128:131], v[32:35], v[16:19], v[128:131]
ds_read_b128 v[60:63], v120 offset:0
v_mfma_f32_16x16x32_bf16 v[132:135], v[32:35], v[20:23], v[132:135]
ds_read_b64_tr_b16 v[76:77], v121 offset:14336
v_mfma_f32_16x16x32_bf16 v[136:139], v[32:35], v[24:27], v[136:139]
ds_read_b64_tr_b16 v[78:79], v121 offset:16128
v_mfma_f32_16x16x32_bf16 v[140:143], v[32:35], v[28:31], v[140:143]
ds_read_b128 v[64:67], v120 offset:2048
v_mfma_f32_16x16x32_bf16 v[144:147], v[36:39], v[16:19], v[144:147]
ds_read_b64_tr_b16 v[80:81], v122 offset:14368
v_mfma_f32_16x16x32_bf16 v[148:151], v[36:39], v[20:23], v[148:151]
ds_read_b64_tr_b16 v[82:83], v122 offset:16160
v_mfma_f32_16x16x32_bf16 v[152:155], v[36:39], v[24:27], v[152:155]
ds_read_b128 v[68:71], v120 offset:4096
v_mfma_f32_16x16x32_bf16 v[156:159], v[36:39], v[28:31], v[156:159]
ds_read_b64_tr_b16 v[84:85], v121 offset:14400
v_mfma_f32_16x16x32_bf16 v[160:163], v[40:43], v[16:19], v[160:163]
ds_read_b64_tr_b16 v[86:87], v121 offset:16192
v_mfma_f32_16x16x32_bf16 v[164:167], v[40:43], v[20:23], v[164:167]
ds_read_b128 v[72:75], v120 offset:6144
v_mfma_f32_16x16x32_bf16 v[168:171], v[40:43], v[24:27], v[168:171]
ds_read_b64_tr_b16 v[88:89], v122 offset:14432
v_mfma_f32_16x16x32_bf16 v[172:175], v[40:43], v[28:31], v[172:175]
ds_read_b64_tr_b16 v[90:91], v122 offset:16224
v_mfma_f32_16x16x32_bf16 v[176:179], v[44:47], v[16:19], v[176:179]
ds_read_b64_tr_b16 v[92:93], v121 offset:14464
v_mfma_f32_16x16x32_bf16 v[180:183], v[44:47], v[20:23], v[180:183]
ds_read_b64_tr_b16 v[94:95], v121 offset:16256
v_mfma_f32_16x16x32_bf16 v[184:187], v[44:47], v[24:27], v[184:187]
ds_read_b64_tr_b16 v[96:97], v122 offset:14496
v_mfma_f32_16x16x32_bf16 v[188:191], v[44:47], v[28:31], v[188:191]
ds_read_b64_tr_b16 v[98:99], v122 offset:16288
v_mfma_f32_16x16x32_bf16 v[192:195], v[48:51], v[16:19], v[192:195]
ds_read_b64_tr_b16 v[100:101], v121 offset:14528
v_mfma_f32_16x16x32_bf16 v[196:199], v[48:51], v[20:23], v[196:199]
ds_read_b64_tr_b16 v[102:103], v121 offset:16320
v_mfma_f32_16x16x32_bf16 v[200:203], v[48:51], v[24:27], v[200:203]
s_add_u32 s93, s93, 45056
v_mfma_f32_16x16x32_bf16 v[204:207], v[48:51], v[28:31], v[204:207]
s_cmp_eq_u32 s93, 135168
v_mfma_f32_16x16x32_bf16 v[208:211], v[52:55], v[16:19], v[208:211]
s_cselect_b32 s93, 0, s93
v_mfma_f32_16x16x32_bf16 v[212:215], v[52:55], v[20:23], v[212:215]
v_add_u32 v119, s93, v240
v_mfma_f32_16x16x32_bf16 v[216:219], v[52:55], v[24:27], v[216:219]
v_mfma_f32_16x16x32_bf16 v[220:223], v[52:55], v[28:31], v[220:223]
v_mfma_f32_16x16x32_bf16 v[224:227], v[56:59], v[16:19], v[224:227]
v_mfma_f32_16x16x32_bf16 v[228:231], v[56:59], v[20:23], v[228:231]
v_mfma_f32_16x16x32_bf16 v[232:235], v[56:59], v[24:27], v[232:235]
v_mfma_f32_16x16x32_bf16 v[236:239], v[56:59], v[28:31], v[236:239]
s_waitcnt lgkmcnt(0)
s_barrier
v_mfma_f32_16x16x32_bf16 v[128:131], v[76:79], v[60:63], v[128:131]
v_add_u32 v121, s93, v242
v_add_u32 v122, s93, v243
v_mfma_f32_16x16x32_bf16 v[132:135], v[76:79], v[64:67], v[132:135]
ds_read_b128 v[16:19], v119 offset:0
v_mfma_f32_16x16x32_bf16 v[136:139], v[76:79], v[68:71], v[136:139]
ds_read_b64_tr_b16 v[32:33], v121 offset:0
v_mfma_f32_16x16x32_bf16 v[140:143], v[76:79], v[72:75], v[140:143]
ds_read_b64_tr_b16 v[34:35], v121 offset:1792
v_mfma_f32_16x16x32_bf16 v[144:147], v[80:83], v[60:63], v[144:147]
ds_read_b128 v[20:23], v119 offset:2048
v_mfma_f32_16x16x32_bf16 v[148:151], v[80:83], v[64:67], v[148:151]
ds_read_b64_tr_b16 v[36:37], v122 offset:32
v_mfma_f32_16x16x32_bf16 v[152:155], v[80:83], v[68:71], v[152:155]
ds_read_b64_tr_b16 v[38:39], v122 offset:1824
v_mfma_f32_16x16x32_bf16 v[156:159], v[80:83], v[72:75], v[156:159]
ds_read_b128 v[24:27], v119 offset:4096
v_mfma_f32_16x16x32_bf16 v[160:163], v[84:87], v[60:63], v[160:163]
ds_read_b64_tr_b16 v[40:41], v121 offset:64
v_mfma_f32_16x16x32_bf16 v[164:167], v[84:87], v[64:67], v[164:167]
ds_read_b64_tr_b16 v[42:43], v121 offset:1856
v_mfma_f32_16x16x32_bf16 v[168:171], v[84:87], v[68:71], v[168:171]
ds_read_b128 v[28:31], v119 offset:6144
v_mfma_f32_16x16x32_bf16 v[172:175], v[84:87], v[72:75], v[172:175]
ds_read_b64_tr_b16 v[44:45], v122 offset:96
v_mfma_f32_16x16x32_bf16 v[176:179], v[88:91], v[60:63], v[176:179]
ds_read_b64_tr_b16 v[46:47], v122 offset:1888
v_mfma_f32_16x16x32_bf16 v[180:183], v[88:91], v[64:67], v[180:183]
ds_read_b64_tr_b16 v[48:49], v121 offset:128
v_mfma_f32_16x16x32_bf16 v[184:187], v[88:91], v[68:71], v[184:187]
ds_read_b64_tr_b16 v[50:51], v121 offset:1920
v_mfma_f32_16x16x32_bf16 v[188:191], v[88:91], v[72:75], v[188:191]
ds_read_b64_tr_b16 v[52:53], v122 offset:160
v_mfma_f32_16x16x32_bf16 v[192:195], v[92:95], v[60:63], v[192:195]
ds_read_b64_tr_b16 v[54:55], v122 offset:1952
v_mfma_f32_16x16x32_bf16 v[196:199], v[92:95], v[64:67], v[196:199]
ds_read_b64_tr_b16 v[56:57], v121 offset:192
v_mfma_f32_16x16x32_bf16 v[200:203], v[92:95], v[68:71], v[200:203]
ds_read_b64_tr_b16 v[58:59], v121 offset:1984
v_mfma_f32_16x16x32_bf16 v[204:207], v[92:95], v[72:75], v[204:207]
v_add_u32 v120, s93, v241
v_mfma_f32_16x16x32_bf16 v[208:211], v[96:99], v[60:63], v[208:211]
s_add_u32 s94, s94, 1
v_mfma_f32_16x16x32_bf16 v[212:215], v[96:99], v[64:67], v[212:215]
s_cmp_lt_u32 s94, 16
v_mfma_f32_16x16x32_bf16 v[216:219], v[96:99], v[68:71], v[216:219]
v_mfma_f32_16x16x32_bf16 v[220:223], v[96:99], v[72:75], v[220:223]
v_mfma_f32_16x16x32_bf16 v[224:227], v[100:103], v[60:63], v[224:227]
v_mfma_f32_16x16x32_bf16 v[228:231], v[100:103], v[64:67], v[228:231]
v_mfma_f32_16x16x32_bf16 v[232:235], v[100:103], v[68:71], v[232:235]
v_mfma_f32_16x16x32_bf16 v[236:239], v[100:103], v[72:75], v[236:239]
s_waitcnt lgkmcnt(0)
s_cbranch_scc1 L_g1loop
s_mul_i32 s40, s22, 917504
s_lshr_b32 s31, s23, 1
s_mul_i32 s31, s31, 114688
s_add_u32 s40, s40, s31
s_mul_i32 s31, s26, 57344
s_add_u32 s40, s40, s31
s_and_b32 s31, s23, 1
s_mul_i32 s31, s31, 28
s_mul_i32 s32, s27, 14
s_add_u32 s31, s31, s32
s_lshl_b32 s31, s31, 10
s_add_u32 s40, s40, s31
s_add_u32 s41, s40, 4096
s_add_u32 s42, s40, 8192
s_add_u32 s43, s40, 12288
v_and_b32 v6, 1, v4
v_lshrrev_b32 v7, 1, v4
v_lshlrev_b32 v8, 4, v3
v_lshlrev_b32 v13, 11, v6
v_lshl_add_u32 v13, v7, 10, v13
v_add_u32 v13, v13, v8
v_lshlrev_b32 v14, 10, v7
v_lshl_add_u32 v14, v6, 8, v14
v_add_u32 v14, v14, v8
v_mov_b32 v11, 0
buffer_load_dword v104, v11, s[76:79], 0 offen sc1
s_and_b32 s35, s23, 6
v_cvt_pk_bf16_f32 v16, v128, v129
v_cvt_pk_bf16_f32 v17, v130, v131
v_pk_max_i16 v16, v16, 0
v_pk_max_i16 v17, v17, 0
v_cvt_pk_bf16_f32 v18, v144, v145
v_cvt_pk_bf16_f32 v19, v146, v147
v_pk_max_i16 v18, v18, 0
v_pk_max_i16 v19, v19, 0
v_cvt_pk_bf16_f32 v20, v160, v161
v_cvt_pk_bf16_f32 v21, v162, v163
v_pk_max_i16 v20, v20, 0
v_pk_max_i16 v21, v21, 0
v_cvt_pk_bf16_f32 v22, v176, v177
v_cvt_pk_bf16_f32 v23, v178, v179
v_pk_max_i16 v22, v22, 0
v_pk_max_i16 v23, v23, 0
v_cvt_pk_bf16_f32 v24, v192, v193
v_cvt_pk_bf16_f32 v25, v194, v195
v_pk_max_i16 v24, v24, 0
v_pk_max_i16 v25, v25, 0
v_cvt_pk_bf16_f32 v26, v208, v209
v_cvt_pk_bf16_f32 v27, v210, v211
v_pk_max_i16 v26, v26, 0
v_pk_max_i16 v27, v27, 0
s_nop 1
v_permlane16_swap_b32 v16, v18
v_permlane16_swap_b32 v17, v19
v_permlane16_swap_b32 v20, v22
v_permlane16_swap_b32 v21, v23
v_permlane16_swap_b32 v24, v26
v_permlane16_swap_b32 v25, v27
s_nop 0
s_cmp_lg_u32 s35, 0
s_cbranch_scc1 L_late0
buffer_store_dwordx4 v[16:19], v13, s[44:47], s40 offen offset:0 sc1
buffer_store_dwordx4 v[20:23], v13, s[44:47], s41 offen offset:0 sc1
buffer_store_dwordx4 v[24:27], v13, s[44:47], s42 offen offset:0 sc1
L_late0:
v_cvt_pk_bf16_f32 v28, v132, v133
v_cvt_pk_bf16_f32 v29, v134, v135
v_pk_max_i16 v28, v28, 0
v_pk_max_i16 v29, v29, 0
v_cvt_pk_bf16_f32 v30, v148, v149
v_cvt_pk_bf16_f32 v31, v150, v151
v_pk_max_i16 v30, v30, 0
v_pk_max_i16 v31, v31, 0
v_cvt_pk_bf16_f32 v32, v164, v165
v_cvt_pk_bf16_f32 v33, v166, v167
v_pk_max_i16 v32, v32, 0
v_pk_max_i16 v33, v33, 0
v_cvt_pk_bf16_f32 v34, v180, v181
v_cvt_pk_bf16_f32 v35, v182, v183
v_pk_max_i16 v34, v34, 0
v_pk_max_i16 v35, v35, 0
v_cvt_pk_bf16_f32 v36, v196, v197
v_cvt_pk_bf16_f32 v37, v198, v199
v_pk_max_i16 v36, v36, 0
v_pk_max_i16 v37, v37, 0
v_cvt_pk_bf16_f32 v38, v212, v213
v_cvt_pk_bf16_f32 v39, v214, v215
v_pk_max_i16 v38, v38, 0
v_pk_max_i16 v39, v39, 0
v_cvt_pk_bf16_f32 v64, v224, v225
v_cvt_pk_bf16_f32 v65, v226, v227
v_pk_max_i16 v64, v64, 0
v_pk_max_i16 v65, v65, 0
v_cvt_pk_bf16_f32 v66, v228, v229
v_cvt_pk_bf16_f32 v67, v230, v231
v_pk_max_i16 v66, v66, 0
v_pk_max_i16 v67, v67, 0
s_nop 1
v_permlane16_swap_b32 v28, v30
v_permlane16_swap_b32 v29, v31
v_permlane16_swap_b32 v32, v34
v_permlane16_swap_b32 v33, v35
v_permlane16_swap_b32 v36, v38
v_permlane16_swap_b32 v37, v39
v_permlane16_swap_b32 v64, v66
v_permlane16_swap_b32 v65, v67
s_nop 0
s_cmp_lg_u32 s35, 0
s_cbranch_scc1 L_late1
buffer_store_dwordx4 v[28:31], v13, s[44:47], s40 offen offset:256 sc1
buffer_store_dwordx4 v[32:35], v13, s[44:47], s41 offen offset:256 sc1
buffer_store_dwordx4 v[36:39], v13, s[44:47], s42 offen offset:256 sc1
buffer_store_dwordx4 v[64:67], v14, s[44:47], s43 offen offset:0 sc1
L_late1:
v_cvt_pk_bf16_f32 v40, v136, v137
v_cvt_pk_bf16_f32 v41, v138, v139
v_pk_max_i16 v40, v40, 0
v_pk_max_i16 v41, v41, 0
v_cvt_pk_bf16_f32 v42, v152, v153
v_cvt_pk_bf16_f32 v43, v154, v155
v_pk_max_i16 v42, v42, 0
v_pk_max_i16 v43, v43, 0
v_cvt_pk_bf16_f32 v44, v168, v169
v_cvt_pk_bf16_f32 v45, v170, v171
v_pk_max_i16 v44, v44, 0
v_pk_max_i16 v45, v45, 0
v_cvt_pk_bf16_f32 v46, v184, v185
v_cvt_pk_bf16_f32 v47, v186, v187
v_pk_max_i16 v46, v46, 0
v_pk_max_i16 v47, v47, 0
v_cvt_pk_bf16_f32 v48, v200, v201
v_cvt_pk_bf16_f32 v49, v202, v203
v_pk_max_i16 v48, v48, 0
v_pk_max_i16 v49, v49, 0
v_cvt_pk_bf16_f32 v50, v216, v217
v_cvt_pk_bf16_f32 v51, v218, v219
v_pk_max_i16 v50, v50, 0
v_pk_max_i16 v51, v51, 0
s_nop 1
v_permlane16_swap_b32 v40, v42
v_permlane16_swap_b32 v41, v43
v_permlane16_swap_b32 v44, v46
v_permlane16_swap_b32 v45, v47
v_permlane16_swap_b32 v48, v50
v_permlane16_swap_b32 v49, v51
s_nop 0
s_cmp_lg_u32 s35, 0
s_cbranch_scc1 L_late2
buffer_store_dwordx4 v[40:43], v13, s[44:47], s40 offen offset:512 sc1
buffer_store_dwordx4 v[44:47], v13, s[44:47], s41 offen offset:512 sc1
buffer_store_dwordx4 v[48:51], v13, s[44:47], s42 offen offset:512 sc1
L_late2:
v_cvt_pk_bf16_f32 v52, v140, v141
v_cvt_pk_bf16_f32 v53, v142, v143
v_pk_max_i16 v52, v52, 0
v_pk_max_i16 v53, v53, 0
v_cvt_pk_bf16_f32 v54, v156, v157
v_cvt_pk_bf16_f32 v55, v158, v159
v_pk_max_i16 v54, v54, 0
v_pk_max_i16 v55, v55, 0
v_cvt_pk_bf16_f32 v56, v172, v173
v_cvt_pk_bf16_f32 v57, v174, v175
v_pk_max_i16 v56, v56, 0
v_pk_max_i16 v57, v57, 0
v_cvt_pk_bf16_f32 v58, v188, v189
v_cvt_pk_bf16_f32 v59, v190, v191
v_pk_max_i16 v58, v58, 0
v_pk_max_i16 v59, v59, 0
v_cvt_pk_bf16_f32 v60, v204, v205
v_cvt_pk_bf16_f32 v61, v206, v207
v_pk_max_i16 v60, v60, 0
v_pk_max_i16 v61, v61, 0
v_cvt_pk_bf16_f32 v62, v220, v221
v_cvt_pk_bf16_f32 v63, v222, v223
v_pk_max_i16 v62, v62, 0
v_pk_max_i16 v63, v63, 0
v_cvt_pk_bf16_f32 v68, v232, v233
v_cvt_pk_bf16_f32 v69, v234, v235
v_pk_max_i16 v68, v68, 0
v_pk_max_i16 v69, v69, 0
v_cvt_pk_bf16_f32 v70, v236, v237
v_cvt_pk_bf16_f32 v71, v238, v239
v_pk_max_i16 v70, v70, 0
v_pk_max_i16 v71, v71, 0
s_nop 1
v_permlane16_swap_b32 v52, v54
v_permlane16_swap_b32 v53, v55
v_permlane16_swap_b32 v56, v58
v_permlane16_swap_b32 v57, v59
v_permlane16_swap_b32 v60, v62
v_permlane16_swap_b32 v61, v63
v_permlane16_swap_b32 v68, v70
v_permlane16_swap_b32 v69, v71
s_nop 0
s_cmp_lg_u32 s35, 0
s_cbranch_scc1 L_late3
buffer_store_dwordx4 v[52:55], v13, s[44:47], s40 offen offset:768 sc1
buffer_store_dwordx4 v[56:59], v13, s[44:47], s41 offen offset:768 sc1
buffer_store_dwordx4 v[60:63], v13, s[44:47], s42 offen offset:768 sc1
buffer_store_dwordx4 v[68:71], v14, s[44:47], s43 offen offset:512 sc1
L_late3:
s_and_b32 s30, s23, 1
s_mul_i32 s31, s30, 28
s_mul_i32 s32, s27, 14
s_add_u32 s31, s31, s32
s_lshl_b32 s30, s30, 5
s_sub_u32 s31, s31, s30
v_and_b32 v5, 1, v4
v_lshrrev_b32 v6, 1, v4
v_lshl_add_u32 v7, v5, 1, v6
v_add_u32 v7, s31, v7
v_lshrrev_b32 v8, 3, v3
v_lshlrev_b32 v8, 10, v8
v_and_b32 v9, 7, v3
v_lshl_add_u32 v8, v9, 4, v8
s_lshl_b32 s30, s26, 13
v_add_u32 v8, s30, v8
v_lshrrev_b32 v10, 3, v7
v_and_b32 v11, 7, v7
v_lshlrev_b32 v10, 15, v10
v_lshl_add_u32 v10, v11, 7, v10
v_add_u32 v12, v10, v8
v_cmp_gt_u32 vcc, 24, v7
v_add_u32 v7, 4, v7
s_nop 0
s_mov_b64 exec, vcc
ds_write_b128 v12, v[16:19] offset:0
ds_write_b128 v12, v[28:31] offset:2048
ds_write_b128 v12, v[40:43] offset:4096
ds_write_b128 v12, v[52:55] offset:6144
s_mov_b64 exec, -1
v_lshrrev_b32 v10, 3, v7
v_and_b32 v11, 7, v7
v_lshlrev_b32 v10, 15, v10
v_lshl_add_u32 v10, v11, 7, v10
v_add_u32 v12, v10, v8
v_cmp_gt_u32 vcc, 24, v7
v_add_u32 v7, 4, v7
s_nop 0
s_mov_b64 exec, vcc
ds_write_b128 v12, v[20:23] offset:0
ds_write_b128 v12, v[32:35] offset:2048
ds_write_b128 v12, v[44:47] offset:4096
ds_write_b128 v12, v[56:59] offset:6144
s_mov_b64 exec, -1
v_lshrrev_b32 v10, 3, v7
v_and_b32 v11, 7, v7
v_lshlrev_b32 v10, 15, v10
v_lshl_add_u32 v10, v11, 7, v10
v_add_u32 v12, v10, v8
v_cmp_gt_u32 vcc, 24, v7
v_add_u32 v7, 4, v7
s_nop 0
s_mov_b64 exec, vcc
ds_write_b128 v12, v[24:27] offset:0
ds_write_b128 v12, v[36:39] offset:2048
ds_write_b128 v12, v[48:51] offset:4096
ds_write_b128 v12, v[60:63] offset:6144
s_mov_b64 exec, -1
v_add_u32 v7, 12, v6
v_add_u32 v7, s31, v7
v_lshl_add_u32 v8, v5, 11, v8
v_lshrrev_b32 v10, 3, v7
v_and_b32 v11, 7, v7
v_lshlrev_b32 v10, 15, v10
v_lshl_add_u32 v10, v11, 7, v10
v_add_u32 v12, v10, v8
v_cmp_gt_u32 vcc, 24, v7
s_nop 1
s_mov_b64 exec, vcc
ds_write_b128 v12, v[64:67] offset:0
ds_write_b128 v12, v[68:71] offset:4096
s_mov_b64 exec, -1
s_cmp_eq_u32 s35, 0
s_cbranch_scc1 L_early_pub
buffer_store_dwordx4 v[16:19], v13, s[44:47], s40 offen offset:0 sc1
buffer_store_dwordx4 v[20:23], v13, s[44:47], s41 offen offset:0 sc1
buffer_store_dwordx4 v[24:27], v13, s[44:47], s42 offen offset:0 sc1
buffer_store_dwordx4 v[28:31], v13, s[44:47], s40 offen offset:256 sc1
buffer_store_dwordx4 v[32:35], v13, s[44:47], s41 offen offset:256 sc1
buffer_store_dwordx4 v[36:39], v13, s[44:47], s42 offen offset:256 sc1
buffer_store_dwordx4 v[64:67], v14, s[44:47], s43 offen offset:0 sc1
buffer_store_dwordx4 v[40:43], v13, s[44:47], s40 offen offset:512 sc1
buffer_store_dwordx4 v[44:47], v13, s[44:47], s41 offen offset:512 sc1
buffer_store_dwordx4 v[48:51], v13, s[44:47], s42 offen offset:512 sc1
buffer_store_dwordx4 v[52:55], v13, s[44:47], s40 offen offset:768 sc1
buffer_store_dwordx4 v[56:59], v13, s[44:47], s41 offen offset:768 sc1
buffer_store_dwordx4 v[60:63], v13, s[44:47], s42 offen offset:768 sc1
buffer_store_dwordx4 v[68:71], v14, s[44:47], s43 offen offset:512 sc1
s_branch L_early_done
L_early_pub:
s_lshl_b32 s31, s22, 1
s_add_u32 s33, s86, s31
s_lshl_b32 s33, s33, 8
s_and_b32 s31, s23, 7
s_lshl_b32 s31, s31, 2
s_add_u32 s31, s31, s25
s_lshl_b32 s31, s31, 2
s_add_u32 s33, s33, s31
v_mov_b32 v8, 1
v_mov_b32 v9, 0
s_waitcnt vmcnt(0) lgkmcnt(0)
s_mov_b32 s34, 0
L_pubA:
v_readfirstlane_b32 s30, v104
s_cmp_eq_u32 s30, 32
s_cbranch_scc1 L_pubA_ok
s_add_u32 s34, s34, 1
s_cmp_lt_u32 s34, 131072
s_cbranch_scc0 L_pubA_ok
s_sleep 4
buffer_load_dword v104, v9, s[76:79], 0 offen sc1
s_waitcnt vmcnt(0)
s_branch L_pubA
L_pubA_ok:
s_mov_b64 exec, 1
buffer_store_dword v8, v9, s[72:75], s33 offen sc1
s_mov_b64 exec, -1
v_lshrrev_b32 v10, 1, v1
v_lshlrev_b32 v10, 6, v10
v_xor_b32 v11, v1, v4
v_and_b32 v11, 1, v11
v_lshl_add_u32 v10, v11, 5, v10
s_mov_b32 s60, s12
s_mov_b32 s61, s13
s_mov_b32 s62, 0x800
s_mov_b32 s63, 0x20000
buffer_load_dwordx4 v[232:235], v10, s[60:63], 0 offen
buffer_load_dwordx4 v[236:239], v10, s[60:63], 0 offen offset:16
s_branch L_fft
L_early_done:
L_g2setup:
v_lshrrev_b32 v5, 1, v3
v_xor_b32 v5, v5, v4
v_lshlrev_b32 v5, 4, v5
v_lshlrev_b32 v6, 7, v3
v_add_u32 v5, v5, v6
s_lshl_b32 s34, s26, 12
v_add_u32 v224, s34, v5
v_xor_b32 v225, 64, v224
v_lshrrev_b32 v5, 3, v3
v_lshlrev_b32 v5, 10, v5
v_lshl_add_u32 v5, v4, 7, v5
v_and_b32 v6, 7, v3
v_lshl_add_u32 v5, v6, 4, v5
s_lshl_b32 s34, s26, 13
s_lshl_b32 s35, s86, 12
s_add_u32 s30, s34, s35
v_add_u32 v208, s30, v5
s_xor_b32 s35, s35, 4096
s_add_u32 s30, s34, s35
v_add_u32 v209, s30, v5
v_lshlrev_b32 v5, 3, v4
v_lshrrev_b32 v6, 2, v3
v_add_u32 v5, v5, v6
v_lshlrev_b32 v5, 8, v5
v_and_b32 v7, 1, v4
v_lshlrev_b32 v7, 2, v7
v_or_b32 v7, v7, v6
s_lshl_b32 s30, s27, 2
v_xor_b32 v7, s30, v7
v_lshlrev_b32 v7, 5, v7
v_add_u32 v5, v5, v7
v_and_b32 v6, 3, v3
v_lshlrev_b32 v6, 3, v6
v_add_u32 v5, v5, v6
v_add_u32 v210, 16384, v5
v_xor_b32 v211, 32, v210
v_xor_b32 v212, 64, v210
v_xor_b32 v213, 96, v210
v_mov_b32 v214, v208
v_mov_b32 v215, v209
v_mov_b32 v216, v210
v_mov_b32 v217, v211
v_mov_b32 v218, v212
v_mov_b32 v219, v213
v_mov_b32 v128, 0
v_mov_b32 v129, 0
v_mov_b32 v130, 0
v_mov_b32 v131, 0
v_mov_b32 v132, 0
v_mov_b32 v133, 0
v_mov_b32 v134, 0
v_mov_b32 v135, 0
v_mov_b32 v136, 0
v_mov_b32 v137, 0
v_mov_b32 v138, 0
v_mov_b32 v139, 0
v_mov_b32 v140, 0
v_mov_b32 v141, 0
v_mov_b32 v142, 0
v_mov_b32 v143, 0
v_mov_b32 v144, 0
v_mov_b32 v145, 0
v_mov_b32 v146, 0
v_mov_b32 v147, 0
v_mov_b32 v148, 0
v_mov_b32 v149, 0
v_mov_b32 v150, 0
v_mov_b32 v151, 0
v_mov_b32 v152, 0
v_mov_b32 v153, 0
v_mov_b32 v154, 0
v_mov_b32 v155, 0
v_mov_b32 v156, 0
v_mov_b32 v157, 0
v_mov_b32 v158, 0
v_mov_b32 v159, 0
v_mov_b32 v160, 0
v_mov_b32 v161, 0
v_mov_b32 v162, 0
v_mov_b32 v163, 0
v_mov_b32 v164, 0
v_mov_b32 v165, 0
v_mov_b32 v166, 0
v_mov_b32 v167, 0
v_mov_b32 v168, 0
v_mov_b32 v169, 0
v_mov_b32 v170, 0
v_mov_b32 v171, 0
v_mov_b32 v172, 0
v_mov_b32 v173, 0
v_mov_b32 v174, 0
v_mov_b32 v175, 0
v_mov_b32 v176, 0
v_mov_b32 v177, 0
v_mov_b32 v178, 0
v_mov_b32 v179, 0
v_mov_b32 v180, 0
v_mov_b32 v181, 0
v_mov_b32 v182, 0
v_mov_b32 v183, 0
v_mov_b32 v184, 0
v_mov_b32 v185, 0
v_mov_b32 v186, 0
v_mov_b32 v187, 0
v_mov_b32 v188, 0
v_mov_b32 v189, 0
v_mov_b32 v190, 0
v_mov_b32 v191, 0
v_mov_b32 v72, 0
v_mov_b32 v73, 0
v_mov_b32 v74, 0
v_mov_b32 v75, 0
v_mov_b32 v76, 0
v_mov_b32 v77, 0
v_mov_b32 v78, 0
v_mov_b32 v79, 0
v_mov_b32 v80, 0
v_mov_b32 v81, 0
v_mov_b32 v82, 0
v_mov_b32 v83, 0
v_mov_b32 v84, 0
v_mov_b32 v85, 0
v_mov_b32 v86, 0
v_mov_b32 v87, 0
v_mov_b32 v88, 0
v_mov_b32 v89, 0
v_mov_b32 v90, 0
v_mov_b32 v91, 0
v_mov_b32 v92, 0
v_mov_b32 v93, 0
v_mov_b32 v94, 0
v_mov_b32 v95, 0
s_mov_b32 s93, 0
s_mov_b32 s94, 0
s_waitcnt lgkmcnt(0)
s_and_b32 s30, s23, 6
s_cmp_eq_u32 s30, 0
s_cbranch_scc1 L_published
s_lshl_b32 s31, s22, 1
s_add_u32 s33, s86, s31
s_lshl_b32 s33, s33, 8
s_and_b32 s31, s23, 7
s_lshl_b32 s31, s31, 2
s_add_u32 s31, s31, s25
s_lshl_b32 s31, s31, 2
s_add_u32 s33, s33, s31
v_mov_b32 v8, 1
v_mov_b32 v9, 0
s_waitcnt vmcnt(0) lgkmcnt(0)
s_mov_b32 s34, 0
L_pubB:
v_readfirstlane_b32 s30, v104
s_cmp_eq_u32 s30, 32
s_cbranch_scc1 L_pubB_ok
s_add_u32 s34, s34, 1
s_cmp_lt_u32 s34, 131072
s_cbranch_scc0 L_pubB_ok
s_sleep 4
buffer_load_dword v104, v9, s[76:79], 0 offen sc1
s_waitcnt vmcnt(0)
s_branch L_pubB
L_pubB_ok:
s_mov_b64 exec, 1
buffer_store_dword v8, v9, s[72:75], s33 offen sc1
s_mov_b64 exec, -1
L_published:
v_mov_b32 v8, 1
v_mov_b32 v9, 0
v_mov_b32 v64, 0
v_mov_b32 v65, 0
v_mov_b32 v66, 0
v_mov_b32 v67, 0
v_mov_b32 v68, 0
v_mov_b32 v69, 0
v_mov_b32 v70, 0
v_mov_b32 v71, 0
s_barrier
ds_read_b128 v[16:19], v214 offset:0
ds_read_b64_tr_b16 v[32:33], v216 offset:0
ds_read_b64_tr_b16 v[34:35], v216 offset:1024
ds_read_b128 v[20:23], v214 offset:2048
ds_read_b64_tr_b16 v[36:37], v217 offset:0
ds_read_b64_tr_b16 v[38:39], v217 offset:1024
ds_read_b128 v[24:27], v215 offset:0
ds_read_b64_tr_b16 v[40:41], v218 offset:0
ds_read_b64_tr_b16 v[42:43], v218 offset:1024
ds_read_b128 v[28:31], v215 offset:2048
ds_read_b64_tr_b16 v[44:45], v219 offset:0
ds_read_b64_tr_b16 v[46:47], v219 offset:1024
s_waitcnt lgkmcnt(0)
v_mfma_f32_16x16x32_bf16 v[128:131], v[32:35], v[16:19], v[128:131]
ds_read_b128 v[48:51], v214 offset:512
v_mfma_f32_16x16x32_bf16 v[132:135], v[32:35], v[20:23], v[132:135]
ds_read_b64_tr_b16 v[192:193], v216 offset:8192
v_mfma_f32_16x16x32_bf16 v[136:139], v[32:35], v[24:27], v[136:139]
ds_read_b64_tr_b16 v[194:195], v216 offset:9216
v_mfma_f32_16x16x32_bf16 v[140:143], v[32:35], v[28:31], v[140:143]
ds_read_b128 v[52:55], v214 offset:2560
v_mfma_f32_16x16x32_bf16 v[144:147], v[36:39], v[16:19], v[144:147]
ds_read_b64_tr_b16 v[196:197], v217 offset:8192
v_mfma_f32_16x16x32_bf16 v[148:151], v[36:39], v[20:23], v[148:151]
ds_read_b64_tr_b16 v[198:199], v217 offset:9216
v_mfma_f32_16x16x32_bf16 v[152:155], v[36:39], v[24:27], v[152:155]
ds_read_b128 v[56:59], v215 offset:512
v_mfma_f32_16x16x32_bf16 v[156:159], v[36:39], v[28:31], v[156:159]
ds_read_b64_tr_b16 v[200:201], v218 offset:8192
v_mfma_f32_16x16x32_bf16 v[160:163], v[40:43], v[16:19], v[160:163]
ds_read_b64_tr_b16 v[202:203], v218 offset:9216
v_mfma_f32_16x16x32_bf16 v[164:167], v[40:43], v[20:23], v[164:167]
ds_read_b128 v[60:63], v215 offset:2560
v_mfma_f32_16x16x32_bf16 v[168:171], v[40:43], v[24:27], v[168:171]
ds_read_b64_tr_b16 v[204:205], v219 offset:8192
v_mfma_f32_16x16x32_bf16 v[172:175], v[40:43], v[28:31], v[172:175]
ds_read_b64_tr_b16 v[206:207], v219 offset:9216
v_mfma_f32_16x16x32_bf16 v[176:179], v[44:47], v[16:19], v[176:179]
s_add_u32 s93, s93, 32768
v_mfma_f32_16x16x32_bf16 v[180:183], v[44:47], v[20:23], v[180:183]
s_cmp_eq_u32 s93, 163840
v_mfma_f32_16x16x32_bf16 v[184:187], v[44:47], v[24:27], v[184:187]
s_cselect_b32 s93, 0, s93
v_mfma_f32_16x16x32_bf16 v[188:191], v[44:47], v[28:31], v[188:191]
s_waitcnt lgkmcnt(0)
s_barrier
v_mfma_f32_16x16x32_bf16 v[128:131], v[192:195], v[48:51], v[128:131]
v_add_u32 v216, s93, v210
v_add_u32 v217, s93, v211
v_add_u32 v218, s93, v212
v_add_u32 v219, s93, v213
v_add_u32 v214, s93, v208
v_add_u32 v215, s93, v209
v_mfma_f32_16x16x32_bf16 v[132:135], v[192:195], v[52:55], v[132:135]
ds_read_b128 v[16:19], v214 offset:0
v_mfma_f32_16x16x32_bf16 v[136:139], v[192:195], v[56:59], v[136:139]
ds_read_b64_tr_b16 v[32:33], v216 offset:0
v_mfma_f32_16x16x32_bf16 v[140:143], v[192:195], v[60:63], v[140:143]
ds_read_b64_tr_b16 v[34:35], v216 offset:1024
v_mfma_f32_16x16x32_bf16 v[144:147], v[196:199], v[48:51], v[144:147]
ds_read_b128 v[20:23], v214 offset:2048
v_mfma_f32_16x16x32_bf16 v[148:151], v[196:199], v[52:55], v[148:151]
ds_read_b64_tr_b16 v[36:37], v217 offset:0
v_mfma_f32_16x16x32_bf16 v[152:155], v[196:199], v[56:59], v[152:155]
ds_read_b64_tr_b16 v[38:39], v217 offset:1024
v_mfma_f32_16x16x32_bf16 v[156:159], v[196:199], v[60:63], v[156:159]
ds_read_b128 v[24:27], v215 offset:0
v_mfma_f32_16x16x32_bf16 v[160:163], v[200:203], v[48:51], v[160:163]
ds_read_b64_tr_b16 v[40:41], v218 offset:0
v_mfma_f32_16x16x32_bf16 v[164:167], v[200:203], v[52:55], v[164:167]
ds_read_b64_tr_b16 v[42:43], v218 offset:1024
v_mfma_f32_16x16x32_bf16 v[168:171], v[200:203], v[56:59], v[168:171]
ds_read_b128 v[28:31], v215 offset:2048
v_mfma_f32_16x16x32_bf16 v[172:175], v[200:203], v[60:63], v[172:175]
ds_read_b64_tr_b16 v[44:45], v219 offset:0
v_mfma_f32_16x16x32_bf16 v[176:179], v[204:207], v[48:51], v[176:179]
ds_read_b64_tr_b16 v[46:47], v219 offset:1024
v_mfma_f32_16x16x32_bf16 v[180:183], v[204:207], v[52:55], v[180:183]
s_add_u32 s94, s94, 1
v_mfma_f32_16x16x32_bf16 v[184:187], v[204:207], v[56:59], v[184:187]
v_mfma_f32_16x16x32_bf16 v[188:191], v[204:207], v[60:63], v[188:191]
s_waitcnt lgkmcnt(0)
v_mfma_f32_16x16x32_bf16 v[128:131], v[32:35], v[16:19], v[128:131]
ds_read_b128 v[48:51], v214 offset:512
v_mfma_f32_16x16x32_bf16 v[132:135], v[32:35], v[20:23], v[132:135]
ds_read_b64_tr_b16 v[192:193], v216 offset:8192
v_mfma_f32_16x16x32_bf16 v[136:139], v[32:35], v[24:27], v[136:139]
ds_read_b64_tr_b16 v[194:195], v216 offset:9216
v_mfma_f32_16x16x32_bf16 v[140:143], v[32:35], v[28:31], v[140:143]
ds_read_b128 v[52:55], v214 offset:2560
v_mfma_f32_16x16x32_bf16 v[144:147], v[36:39], v[16:19], v[144:147]
ds_read_b64_tr_b16 v[196:197], v217 offset:8192
v_mfma_f32_16x16x32_bf16 v[148:151], v[36:39], v[20:23], v[148:151]
ds_read_b64_tr_b16 v[198:199], v217 offset:9216
v_mfma_f32_16x16x32_bf16 v[152:155], v[36:39], v[24:27], v[152:155]
ds_read_b128 v[56:59], v215 offset:512
v_mfma_f32_16x16x32_bf16 v[156:159], v[36:39], v[28:31], v[156:159]
ds_read_b64_tr_b16 v[200:201], v218 offset:8192
v_mfma_f32_16x16x32_bf16 v[160:163], v[40:43], v[16:19], v[160:163]
ds_read_b64_tr_b16 v[202:203], v218 offset:9216
v_mfma_f32_16x16x32_bf16 v[164:167], v[40:43], v[20:23], v[164:167]
ds_read_b128 v[60:63], v215 offset:2560
v_mfma_f32_16x16x32_bf16 v[168:171], v[40:43], v[24:27], v[168:171]
ds_read_b64_tr_b16 v[204:205], v219 offset:8192
v_mfma_f32_16x16x32_bf16 v[172:175], v[40:43], v[28:31], v[172:175]
ds_read_b64_tr_b16 v[206:207], v219 offset:9216
v_mfma_f32_16x16x32_bf16 v[176:179], v[44:47], v[16:19], v[176:179]
s_add_u32 s93, s93, 32768
v_mfma_f32_16x16x32_bf16 v[180:183], v[44:47], v[20:23], v[180:183]
s_cmp_eq_u32 s93, 163840
v_mfma_f32_16x16x32_bf16 v[184:187], v[44:47], v[24:27], v[184:187]
s_cselect_b32 s93, 0, s93
v_mfma_f32_16x16x32_bf16 v[188:191], v[44:47], v[28:31], v[188:191]
s_waitcnt lgkmcnt(0)
s_barrier
v_mfma_f32_16x16x32_bf16 v[128:131], v[192:195], v[48:51], v[128:131]
v_add_u32 v216, s93, v210
v_add_u32 v217, s93, v211
v_add_u32 v218, s93, v212
v_add_u32 v219, s93, v213
v_add_u32 v214, s93, v208
v_add_u32 v215, s93, v209
v_mfma_f32_16x16x32_bf16 v[132:135], v[192:195], v[52:55], v[132:135]
ds_read_b128 v[16:19], v214 offset:0
v_mfma_f32_16x16x32_bf16 v[136:139], v[192:195], v[56:59], v[136:139]
ds_read_b64_tr_b16 v[32:33], v216 offset:0
v_mfma_f32_16x16x32_bf16 v[140:143], v[192:195], v[60:63], v[140:143]
ds_read_b64_tr_b16 v[34:35], v216 offset:1024
v_mfma_f32_16x16x32_bf16 v[144:147], v[196:199], v[48:51], v[144:147]
ds_read_b128 v[20:23], v214 offset:2048
v_mfma_f32_16x16x32_bf16 v[148:151], v[196:199], v[52:55], v[148:151]
ds_read_b64_tr_b16 v[36:37], v217 offset:0
v_mfma_f32_16x16x32_bf16 v[152:155], v[196:199], v[56:59], v[152:155]
ds_read_b64_tr_b16 v[38:39], v217 offset:1024
v_mfma_f32_16x16x32_bf16 v[156:159], v[196:199], v[60:63], v[156:159]
ds_read_b128 v[24:27], v215 offset:0
v_mfma_f32_16x16x32_bf16 v[160:163], v[200:203], v[48:51], v[160:163]
ds_read_b64_tr_b16 v[40:41], v218 offset:0
v_mfma_f32_16x16x32_bf16 v[164:167], v[200:203], v[52:55], v[164:167]
ds_read_b64_tr_b16 v[42:43], v218 offset:1024
v_mfma_f32_16x16x32_bf16 v[168:171], v[200:203], v[56:59], v[168:171]
ds_read_b128 v[28:31], v215 offset:2048
v_mfma_f32_16x16x32_bf16 v[172:175], v[200:203], v[60:63], v[172:175]
ds_read_b64_tr_b16 v[44:45], v219 offset:0
v_mfma_f32_16x16x32_bf16 v[176:179], v[204:207], v[48:51], v[176:179]
ds_read_b64_tr_b16 v[46:47], v219 offset:1024
v_mfma_f32_16x16x32_bf16 v[180:183], v[204:207], v[52:55], v[180:183]
s_add_u32 s94, s94, 1
v_mfma_f32_16x16x32_bf16 v[184:187], v[204:207], v[56:59], v[184:187]
v_mfma_f32_16x16x32_bf16 v[188:191], v[204:207], v[60:63], v[188:191]
s_waitcnt lgkmcnt(0)
s_waitcnt vmcnt(0)
v_mfma_f32_16x16x32_bf16 v[128:131], v[32:35], v[16:19], v[128:131]
ds_read_b128 v[48:51], v214 offset:512
v_mfma_f32_16x16x32_bf16 v[132:135], v[32:35], v[20:23], v[132:135]
ds_read_b64_tr_b16 v[192:193], v216 offset:8192
v_mfma_f32_16x16x32_bf16 v[136:139], v[32:35], v[24:27], v[136:139]
ds_read_b64_tr_b16 v[194:195], v216 offset:9216
v_mfma_f32_16x16x32_bf16 v[140:143], v[32:35], v[28:31], v[140:143]
ds_read_b128 v[52:55], v214 offset:2560
v_mfma_f32_16x16x32_bf16 v[144:147], v[36:39], v[16:19], v[144:147]
ds_read_b64_tr_b16 v[196:197], v217 offset:8192
v_mfma_f32_16x16x32_bf16 v[148:151], v[36:39], v[20:23], v[148:151]
ds_read_b64_tr_b16 v[198:199], v217 offset:9216
v_mfma_f32_16x16x32_bf16 v[152:155], v[36:39], v[24:27], v[152:155]
ds_read_b128 v[56:59], v215 offset:512
v_mfma_f32_16x16x32_bf16 v[156:159], v[36:39], v[28:31], v[156:159]
ds_read_b64_tr_b16 v[200:201], v218 offset:8192
v_mfma_f32_16x16x32_bf16 v[160:163], v[40:43], v[16:19], v[160:163]
ds_read_b64_tr_b16 v[202:203], v218 offset:9216
v_mfma_f32_16x16x32_bf16 v[164:167], v[40:43], v[20:23], v[164:167]
ds_read_b128 v[60:63], v215 offset:2560
v_mfma_f32_16x16x32_bf16 v[168:171], v[40:43], v[24:27], v[168:171]
ds_read_b64_tr_b16 v[204:205], v219 offset:8192
v_mfma_f32_16x16x32_bf16 v[172:175], v[40:43], v[28:31], v[172:175]
ds_read_b64_tr_b16 v[206:207], v219 offset:9216
v_mfma_f32_16x16x32_bf16 v[176:179], v[44:47], v[16:19], v[176:179]
s_add_u32 s93, s93, 32768
v_mfma_f32_16x16x32_bf16 v[180:183], v[44:47], v[20:23], v[180:183]
s_cmp_eq_u32 s93, 163840
v_mfma_f32_16x16x32_bf16 v[184:187], v[44:47], v[24:27], v[184:187]
s_cselect_b32 s93, 0, s93
v_mfma_f32_16x16x32_bf16 v[188:191], v[44:47], v[28:31], v[188:191]
s_waitcnt lgkmcnt(0)
s_barrier
v_mfma_f32_16x16x32_bf16 v[128:131], v[192:195], v[48:51], v[128:131]
v_add_u32 v216, s93, v210
v_add_u32 v217, s93, v211
v_add_u32 v218, s93, v212
v_add_u32 v219, s93, v213
v_add_u32 v214, s93, v208
v_add_u32 v215, s93, v209
v_mfma_f32_16x16x32_bf16 v[132:135], v[192:195], v[52:55], v[132:135]
ds_read_b128 v[16:19], v214 offset:0
v_mfma_f32_16x16x32_bf16 v[136:139], v[192:195], v[56:59], v[136:139]
ds_read_b64_tr_b16 v[32:33], v216 offset:0
v_mfma_f32_16x16x32_bf16 v[140:143], v[192:195], v[60:63], v[140:143]
ds_read_b64_tr_b16 v[34:35], v216 offset:1024
v_mfma_f32_16x16x32_bf16 v[144:147], v[196:199], v[48:51], v[144:147]
ds_read_b128 v[20:23], v214 offset:2048
v_mfma_f32_16x16x32_bf16 v[148:151], v[196:199], v[52:55], v[148:151]
ds_read_b64_tr_b16 v[36:37], v217 offset:0
v_mfma_f32_16x16x32_bf16 v[152:155], v[196:199], v[56:59], v[152:155]
ds_read_b64_tr_b16 v[38:39], v217 offset:1024
v_mfma_f32_16x16x32_bf16 v[156:159], v[196:199], v[60:63], v[156:159]
ds_read_b128 v[24:27], v215 offset:0
v_mfma_f32_16x16x32_bf16 v[160:163], v[200:203], v[48:51], v[160:163]
ds_read_b64_tr_b16 v[40:41], v218 offset:0
v_mfma_f32_16x16x32_bf16 v[164:167], v[200:203], v[52:55], v[164:167]
ds_read_b64_tr_b16 v[42:43], v218 offset:1024
v_mfma_f32_16x16x32_bf16 v[168:171], v[200:203], v[56:59], v[168:171]
ds_read_b128 v[28:31], v215 offset:2048
v_mfma_f32_16x16x32_bf16 v[172:175], v[200:203], v[60:63], v[172:175]
ds_read_b64_tr_b16 v[44:45], v219 offset:0
v_mfma_f32_16x16x32_bf16 v[176:179], v[204:207], v[48:51], v[176:179]
ds_read_b64_tr_b16 v[46:47], v219 offset:1024
v_mfma_f32_16x16x32_bf16 v[180:183], v[204:207], v[52:55], v[180:183]
s_add_u32 s94, s94, 1
v_mfma_f32_16x16x32_bf16 v[184:187], v[204:207], v[56:59], v[184:187]
v_mfma_f32_16x16x32_bf16 v[188:191], v[204:207], v[60:63], v[188:191]
s_waitcnt lgkmcnt(0)
s_cmp_eq_u32 s25, 0
s_cbranch_scc0 L_g2_h3
v_mov_b32 v8, 1
v_mov_b32 v9, 0
s_mov_b64 exec, 1
buffer_atomic_add v8, v9, s[76:79], 0 offen offset:128 sc1
s_mov_b64 exec, -1
L_g2_h3:
.p2align 6
L_g2loop:
v_mfma_f32_16x16x32_bf16 v[128:131], v[32:35], v[16:19], v[128:131]
ds_read_b128 v[48:51], v214 offset:512
v_mfma_f32_16x16x32_bf16 v[132:135], v[32:35], v[20:23], v[132:135]
ds_read_b64_tr_b16 v[192:193], v216 offset:8192
v_mfma_f32_16x16x32_bf16 v[136:139], v[32:35], v[24:27], v[136:139]
ds_read_b64_tr_b16 v[194:195], v216 offset:9216
v_mfma_f32_16x16x32_bf16 v[140:143], v[32:35], v[28:31], v[140:143]
ds_read_b128 v[52:55], v214 offset:2560
v_mfma_f32_16x16x32_bf16 v[144:147], v[36:39], v[16:19], v[144:147]
ds_read_b64_tr_b16 v[196:197], v217 offset:8192
v_mfma_f32_16x16x32_bf16 v[148:151], v[36:39], v[20:23], v[148:151]
ds_read_b64_tr_b16 v[198:199], v217 offset:9216
v_mfma_f32_16x16x32_bf16 v[152:155], v[36:39], v[24:27], v[152:155]
ds_read_b128 v[56:59], v215 offset:512
v_mfma_f32_16x16x32_bf16 v[156:159], v[36:39], v[28:31], v[156:159]
ds_read_b64_tr_b16 v[200:201], v218 offset:8192
v_mfma_f32_16x16x32_bf16 v[160:163], v[40:43], v[16:19], v[160:163]
ds_read_b64_tr_b16 v[202:203], v218 offset:9216
v_mfma_f32_16x16x32_bf16 v[164:167], v[40:43], v[20:23], v[164:167]
ds_read_b128 v[60:63], v215 offset:2560
v_mfma_f32_16x16x32_bf16 v[168:171], v[40:43], v[24:27], v[168:171]
ds_read_b64_tr_b16 v[204:205], v219 offset:8192
v_mfma_f32_16x16x32_bf16 v[172:175], v[40:43], v[28:31], v[172:175]
ds_read_b64_tr_b16 v[206:207], v219 offset:9216
v_mfma_f32_16x16x32_bf16 v[176:179], v[44:47], v[16:19], v[176:179]
s_add_u32 s93, s93, 32768
v_mfma_f32_16x16x32_bf16 v[180:183], v[44:47], v[20:23], v[180:183]
s_cmp_eq_u32 s93, 163840
v_mfma_f32_16x16x32_bf16 v[184:187], v[44:47], v[24:27], v[184:187]
s_cselect_b32 s93, 0, s93
v_mfma_f32_16x16x32_bf16 v[188:191], v[44:47], v[28:31], v[188:191]
s_waitcnt lgkmcnt(0)
s_barrier
v_mfma_f32_16x16x32_bf16 v[128:131], v[192:195], v[48:51], v[128:131]
v_add_u32 v216, s93, v210
v_add_u32 v217, s93, v211
v_add_u32 v218, s93, v212
v_add_u32 v219, s93, v213
v_add_u32 v214, s93, v208
v_add_u32 v215, s93, v209
v_mfma_f32_16x16x32_bf16 v[132:135], v[192:195], v[52:55], v[132:135]
ds_read_b128 v[16:19], v214 offset:0
v_mfma_f32_16x16x32_bf16 v[136:139], v[192:195], v[56:59], v[136:139]
ds_read_b64_tr_b16 v[32:33], v216 offset:0
v_mfma_f32_16x16x32_bf16 v[140:143], v[192:195], v[60:63], v[140:143]
ds_read_b64_tr_b16 v[34:35], v216 offset:1024
v_mfma_f32_16x16x32_bf16 v[144:147], v[196:199], v[48:51], v[144:147]
ds_read_b128 v[20:23], v214 offset:2048
v_mfma_f32_16x16x32_bf16 v[148:151], v[196:199], v[52:55], v[148:151]
ds_read_b64_tr_b16 v[36:37], v217 offset:0
v_mfma_f32_16x16x32_bf16 v[152:155], v[196:199], v[56:59], v[152:155]
ds_read_b64_tr_b16 v[38:39], v217 offset:1024
v_mfma_f32_16x16x32_bf16 v[156:159], v[196:199], v[60:63], v[156:159]
ds_read_b128 v[24:27], v215 offset:0
v_mfma_f32_16x16x32_bf16 v[160:163], v[200:203], v[48:51], v[160:163]
ds_read_b64_tr_b16 v[40:41], v218 offset:0
v_mfma_f32_16x16x32_bf16 v[164:167], v[200:203], v[52:55], v[164:167]
ds_read_b64_tr_b16 v[42:43], v218 offset:1024
v_mfma_f32_16x16x32_bf16 v[168:171], v[200:203], v[56:59], v[168:171]
ds_read_b128 v[28:31], v215 offset:2048
v_mfma_f32_16x16x32_bf16 v[172:175], v[200:203], v[60:63], v[172:175]
ds_read_b64_tr_b16 v[44:45], v219 offset:0
v_mfma_f32_16x16x32_bf16 v[176:179], v[204:207], v[48:51], v[176:179]
ds_read_b64_tr_b16 v[46:47], v219 offset:1024
v_mfma_f32_16x16x32_bf16 v[180:183], v[204:207], v[52:55], v[180:183]
s_add_u32 s94, s94, 1
v_mfma_f32_16x16x32_bf16 v[184:187], v[204:207], v[56:59], v[184:187]
s_cmp_lt_u32 s94, 27
v_mfma_f32_16x16x32_bf16 v[188:191], v[204:207], v[60:63], v[188:191]
s_waitcnt lgkmcnt(0)
s_cbranch_scc1 L_g2loop
s_lshl_b32 s30, s22, 9
s_lshl_b32 s31, s26, 8
s_add_u32 s30, s30, s31
s_lshl_b32 s31, s86, 7
s_add_u32 s32, s30, s31
s_xor_b32 s31, s31, 128
s_add_u32 s33, s30, s31
v_lshlrev_b32 v5, 2, v3
buffer_load_dword v220, v5, s[56:59], s32 offen offset:0 sc1
buffer_load_dword v221, v5, s[56:59], s32 offen offset:64 sc1
buffer_load_dword v222, v5, s[56:59], s33 offen offset:0 sc1
buffer_load_dword v223, v5, s[56:59], s33 offen offset:64 sc1
v_mfma_f32_16x16x32_bf16 v[128:131], v[32:35], v[16:19], v[128:131]
ds_read_b128 v[48:51], v214 offset:512
v_mfma_f32_16x16x32_bf16 v[132:135], v[32:35], v[20:23], v[132:135]
ds_read_b64_tr_b16 v[192:193], v216 offset:8192
v_mfma_f32_16x16x32_bf16 v[136:139], v[32:35], v[24:27], v[136:139]
ds_read_b64_tr_b16 v[194:195], v216 offset:9216
v_mfma_f32_16x16x32_bf16 v[140:143], v[32:35], v[28:31], v[140:143]
ds_read_b128 v[52:55], v214 offset:2560
v_mfma_f32_16x16x32_bf16 v[144:147], v[36:39], v[16:19], v[144:147]
ds_read_b64_tr_b16 v[196:197], v217 offset:8192
v_mfma_f32_16x16x32_bf16 v[148:151], v[36:39], v[20:23], v[148:151]
ds_read_b64_tr_b16 v[198:199], v217 offset:9216
v_mfma_f32_16x16x32_bf16 v[152:155], v[36:39], v[24:27], v[152:155]
ds_read_b128 v[56:59], v215 offset:512
v_mfma_f32_16x16x32_bf16 v[156:159], v[36:39], v[28:31], v[156:159]
ds_read_b64_tr_b16 v[200:201], v218 offset:8192
v_mfma_f32_16x16x32_bf16 v[160:163], v[40:43], v[16:19], v[160:163]
ds_read_b64_tr_b16 v[202:203], v218 offset:9216
v_mfma_f32_16x16x32_bf16 v[164:167], v[40:43], v[20:23], v[164:167]
ds_read_b128 v[60:63], v215 offset:2560
v_mfma_f32_16x16x32_bf16 v[168:171], v[40:43], v[24:27], v[168:171]
ds_read_b64_tr_b16 v[204:205], v219 offset:8192
v_mfma_f32_16x16x32_bf16 v[172:175], v[40:43], v[28:31], v[172:175]
ds_read_b64_tr_b16 v[206:207], v219 offset:9216
v_mfma_f32_16x16x32_bf16 v[176:179], v[44:47], v[16:19], v[176:179]
s_add_u32 s93, s93, 32768
v_mfma_f32_16x16x32_bf16 v[180:183], v[44:47], v[20:23], v[180:183]
s_cmp_eq_u32 s93, 163840
v_mfma_f32_16x16x32_bf16 v[184:187], v[44:47], v[24:27], v[184:187]
s_cselect_b32 s93, 0, s93
v_mfma_f32_16x16x32_bf16 v[188:191], v[44:47], v[28:31], v[188:191]
s_waitcnt lgkmcnt(0)
s_barrier
v_mfma_f32_16x16x32_bf16 v[128:131], v[192:195], v[48:51], v[128:131]
v_add_u32 v216, s93, v210
v_add_u32 v217, s93, v211
v_add_u32 v218, s93, v212
v_add_u32 v219, s93, v213
v_add_u32 v214, s93, v208
v_add_u32 v215, s93, v209
v_mfma_f32_16x16x32_bf16 v[132:135], v[192:195], v[52:55], v[132:135]
ds_read_b128 v[16:19], v214 offset:0
v_mfma_f32_16x16x32_bf16 v[136:139], v[192:195], v[56:59], v[136:139]
ds_read_b64_tr_b16 v[32:33], v216 offset:0
v_mfma_f32_16x16x32_bf16 v[140:143], v[192:195], v[60:63], v[140:143]
ds_read_b64_tr_b16 v[34:35], v216 offset:1024
v_mfma_f32_16x16x32_bf16 v[144:147], v[196:199], v[48:51], v[144:147]
ds_read_b128 v[20:23], v214 offset:2048
v_mfma_f32_16x16x32_bf16 v[148:151], v[196:199], v[52:55], v[148:151]
ds_read_b64_tr_b16 v[36:37], v217 offset:0
v_mfma_f32_16x16x32_bf16 v[152:155], v[196:199], v[56:59], v[152:155]
ds_read_b64_tr_b16 v[38:39], v217 offset:1024
v_mfma_f32_16x16x32_bf16 v[156:159], v[196:199], v[60:63], v[156:159]
ds_read_b128 v[24:27], v215 offset:0
v_mfma_f32_16x16x32_bf16 v[160:163], v[200:203], v[48:51], v[160:163]
ds_read_b64_tr_b16 v[40:41], v218 offset:0
v_mfma_f32_16x16x32_bf16 v[164:167], v[200:203], v[52:55], v[164:167]
ds_read_b64_tr_b16 v[42:43], v218 offset:1024
v_mfma_f32_16x16x32_bf16 v[168:171], v[200:203], v[56:59], v[168:171]
ds_read_b128 v[28:31], v215 offset:2048
v_mfma_f32_16x16x32_bf16 v[172:175], v[200:203], v[60:63], v[172:175]
ds_read_b64_tr_b16 v[44:45], v219 offset:0
v_mfma_f32_16x16x32_bf16 v[176:179], v[204:207], v[48:51], v[176:179]
ds_read_b64_tr_b16 v[46:47], v219 offset:1024
v_mfma_f32_16x16x32_bf16 v[180:183], v[204:207], v[52:55], v[180:183]
s_add_u32 s94, s94, 1
v_mfma_f32_16x16x32_bf16 v[184:187], v[204:207], v[56:59], v[184:187]
v_mfma_f32_16x16x32_bf16 v[188:191], v[204:207], v[60:63], v[188:191]
s_waitcnt lgkmcnt(0)
s_lshl_b32 s30, s22, 3
s_add_u32 s30, s30, s85
s_lshl_b32 s30, s30, 1
s_xor_b32 s31, s86, 1
s_add_u32 s32, s30, s31
s_lshl_b32 s32, s32, 2
s_add_u32 s32, s32, s25
s_lshl_b32 s32, s32, 12
s_add_u32 s33, s30, s86
s_lshl_b32 s33, s33, 2
s_add_u32 s33, s33, s25
s_lshl_b32 s33, s33, 12
v_lshlrev_b32 v5, 4, v1
s_waitcnt vmcnt(0)
v_sub_f32 v8, 1.0, v220
v_sub_f32 v9, 1.0, v221
v_sub_f32 v10, 1.0, v222
v_sub_f32 v11, 1.0, v223
v_mul_f32 v112, v136, v10
v_mul_f32 v113, v137, v10
v_mul_f32 v114, v138, v10
v_mul_f32 v115, v139, v10
v_cvt_pk_bf16_f32 v96, v112, v113
v_cvt_pk_bf16_f32 v97, v114, v115
v_mul_f32 v112, v140, v11
v_mul_f32 v113, v141, v11
v_mul_f32 v114, v142, v11
v_mul_f32 v115, v143, v11
v_cvt_pk_bf16_f32 v98, v112, v113
v_cvt_pk_bf16_f32 v99, v114, v115
buffer_store_dwordx4 v[96:99], v5, s[52:55], s32 offen offset:0 sc1
v_mul_f32 v112, v152, v10
v_mul_f32 v113, v153, v10
v_mul_f32 v114, v154, v10
v_mul_f32 v115, v155, v10
v_cvt_pk_bf16_f32 v100, v112, v113
v_cvt_pk_bf16_f32 v101, v114, v115
v_mul_f32 v112, v156, v11
v_mul_f32 v113, v157, v11
v_mul_f32 v114, v158, v11
v_mul_f32 v115, v159, v11
v_cvt_pk_bf16_f32 v102, v112, v113
v_cvt_pk_bf16_f32 v103, v114, v115
buffer_store_dwordx4 v[100:103], v5, s[52:55], s32 offen offset:1024 sc1
v_mul_f32 v112, v168, v10
v_mul_f32 v113, v169, v10
v_mul_f32 v114, v170, v10
v_mul_f32 v115, v171, v10
v_cvt_pk_bf16_f32 v104, v112, v113
v_cvt_pk_bf16_f32 v105, v114, v115
v_mul_f32 v112, v172, v11
v_mul_f32 v113, v173, v11
v_mul_f32 v114, v174, v11
v_mul_f32 v115, v175, v11
v_cvt_pk_bf16_f32 v106, v112, v113
v_cvt_pk_bf16_f32 v107, v114, v115
buffer_store_dwordx4 v[104:107], v5, s[52:55], s32 offen offset:2048 sc1
v_mul_f32 v112, v184, v10
v_mul_f32 v113, v185, v10
v_mul_f32 v114, v186, v10
v_mul_f32 v115, v187, v10
v_cvt_pk_bf16_f32 v108, v112, v113
v_cvt_pk_bf16_f32 v109, v114, v115
v_mul_f32 v112, v188, v11
v_mul_f32 v113, v189, v11
v_mul_f32 v114, v190, v11
v_mul_f32 v115, v191, v11
v_cvt_pk_bf16_f32 v110, v112, v113
v_cvt_pk_bf16_f32 v111, v114, v115
buffer_store_dwordx4 v[108:111], v5, s[52:55], s32 offen offset:3072 sc1
v_add_u32 v214, s93, v224
v_add_u32 v215, s93, v225
ds_read_b128 v[16:19], v214 offset:0
ds_read_b64_tr_b16 v[32:33], v216 offset:0
ds_read_b64_tr_b16 v[34:35], v216 offset:1024
ds_read_b128 v[20:23], v214 offset:2048
ds_read_b64_tr_b16 v[36:37], v217 offset:0
ds_read_b64_tr_b16 v[38:39], v217 offset:1024
ds_read_b64_tr_b16 v[40:41], v218 offset:0
ds_read_b64_tr_b16 v[42:43], v218 offset:1024
ds_read_b64_tr_b16 v[44:45], v219 offset:0
ds_read_b64_tr_b16 v[46:47], v219 offset:1024
s_waitcnt lgkmcnt(0)
v_mfma_f32_16x16x32_bf16 v[64:67], v[32:35], v[16:19], v[64:67]
ds_read_b128 v[48:51], v215 offset:0
ds_read_b64_tr_b16 v[192:193], v216 offset:8192
v_mfma_f32_16x16x32_bf16 v[68:71], v[32:35], v[20:23], v[68:71]
ds_read_b64_tr_b16 v[194:195], v216 offset:9216
ds_read_b128 v[52:55], v215 offset:2048
v_mfma_f32_16x16x32_bf16 v[72:75], v[36:39], v[16:19], v[72:75]
ds_read_b64_tr_b16 v[196:197], v217 offset:8192
ds_read_b64_tr_b16 v[198:199], v217 offset:9216
v_mfma_f32_16x16x32_bf16 v[76:79], v[36:39], v[20:23], v[76:79]
ds_read_b64_tr_b16 v[200:201], v218 offset:8192
ds_read_b64_tr_b16 v[202:203], v218 offset:9216
v_mfma_f32_16x16x32_bf16 v[80:83], v[40:43], v[16:19], v[80:83]
ds_read_b64_tr_b16 v[204:205], v219 offset:8192
ds_read_b64_tr_b16 v[206:207], v219 offset:9216
v_mfma_f32_16x16x32_bf16 v[84:87], v[40:43], v[20:23], v[84:87]
s_add_u32 s93, s93, 32768
s_cmp_eq_u32 s93, 163840
v_mfma_f32_16x16x32_bf16 v[88:91], v[44:47], v[16:19], v[88:91]
s_cselect_b32 s93, 0, s93
v_add_u32 v214, s93, v224
v_mfma_f32_16x16x32_bf16 v[92:95], v[44:47], v[20:23], v[92:95]
s_waitcnt lgkmcnt(0)
s_barrier
v_mfma_f32_16x16x32_bf16 v[64:67], v[192:195], v[48:51], v[64:67]
v_add_u32 v216, s93, v210
v_add_u32 v217, s93, v211
v_add_u32 v218, s93, v212
v_add_u32 v219, s93, v213
v_mfma_f32_16x16x32_bf16 v[68:71], v[192:195], v[52:55], v[68:71]
ds_read_b128 v[16:19], v214 offset:0
ds_read_b64_tr_b16 v[32:33], v216 offset:0
v_mfma_f32_16x16x32_bf16 v[72:75], v[196:199], v[48:51], v[72:75]
ds_read_b64_tr_b16 v[34:35], v216 offset:1024
ds_read_b128 v[20:23], v214 offset:2048
v_mfma_f32_16x16x32_bf16 v[76:79], v[196:199], v[52:55], v[76:79]
ds_read_b64_tr_b16 v[36:37], v217 offset:0
ds_read_b64_tr_b16 v[38:39], v217 offset:1024
v_mfma_f32_16x16x32_bf16 v[80:83], v[200:203], v[48:51], v[80:83]
ds_read_b64_tr_b16 v[40:41], v218 offset:0
ds_read_b64_tr_b16 v[42:43], v218 offset:1024
v_mfma_f32_16x16x32_bf16 v[84:87], v[200:203], v[52:55], v[84:87]
ds_read_b64_tr_b16 v[44:45], v219 offset:0
ds_read_b64_tr_b16 v[46:47], v219 offset:1024
v_mfma_f32_16x16x32_bf16 v[88:91], v[204:207], v[48:51], v[88:91]
v_add_u32 v215, s93, v225
v_mfma_f32_16x16x32_bf16 v[92:95], v[204:207], v[52:55], v[92:95]
s_waitcnt lgkmcnt(0)
v_mfma_f32_16x16x32_bf16 v[64:67], v[32:35], v[16:19], v[64:67]
ds_read_b128 v[48:51], v215 offset:0
ds_read_b64_tr_b16 v[192:193], v216 offset:8192
v_mfma_f32_16x16x32_bf16 v[68:71], v[32:35], v[20:23], v[68:71]
ds_read_b64_tr_b16 v[194:195], v216 offset:9216
ds_read_b128 v[52:55], v215 offset:2048
v_mfma_f32_16x16x32_bf16 v[72:75], v[36:39], v[16:19], v[72:75]
ds_read_b64_tr_b16 v[196:197], v217 offset:8192
ds_read_b64_tr_b16 v[198:199], v217 offset:9216
v_mfma_f32_16x16x32_bf16 v[76:79], v[36:39], v[20:23], v[76:79]
ds_read_b64_tr_b16 v[200:201], v218 offset:8192
ds_read_b64_tr_b16 v[202:203], v218 offset:9216
v_mfma_f32_16x16x32_bf16 v[80:83], v[40:43], v[16:19], v[80:83]
ds_read_b64_tr_b16 v[204:205], v219 offset:8192
ds_read_b64_tr_b16 v[206:207], v219 offset:9216
v_mfma_f32_16x16x32_bf16 v[84:87], v[40:43], v[20:23], v[84:87]
s_add_u32 s93, s93, 32768
s_cmp_eq_u32 s93, 163840
v_mfma_f32_16x16x32_bf16 v[88:91], v[44:47], v[16:19], v[88:91]
s_cselect_b32 s93, 0, s93
v_add_u32 v214, s93, v224
v_mfma_f32_16x16x32_bf16 v[92:95], v[44:47], v[20:23], v[92:95]
s_waitcnt lgkmcnt(0)
s_barrier
v_mfma_f32_16x16x32_bf16 v[64:67], v[192:195], v[48:51], v[64:67]
v_add_u32 v216, s93, v210
v_add_u32 v217, s93, v211
v_add_u32 v218, s93, v212
v_add_u32 v219, s93, v213
v_mfma_f32_16x16x32_bf16 v[68:71], v[192:195], v[52:55], v[68:71]
ds_read_b128 v[16:19], v214 offset:0
ds_read_b64_tr_b16 v[32:33], v216 offset:0
v_mfma_f32_16x16x32_bf16 v[72:75], v[196:199], v[48:51], v[72:75]
ds_read_b64_tr_b16 v[34:35], v216 offset:1024
ds_read_b128 v[20:23], v214 offset:2048
v_mfma_f32_16x16x32_bf16 v[76:79], v[196:199], v[52:55], v[76:79]
ds_read_b64_tr_b16 v[36:37], v217 offset:0
ds_read_b64_tr_b16 v[38:39], v217 offset:1024
v_mfma_f32_16x16x32_bf16 v[80:83], v[200:203], v[48:51], v[80:83]
ds_read_b64_tr_b16 v[40:41], v218 offset:0
ds_read_b64_tr_b16 v[42:43], v218 offset:1024
v_mfma_f32_16x16x32_bf16 v[84:87], v[200:203], v[52:55], v[84:87]
ds_read_b64_tr_b16 v[44:45], v219 offset:0
ds_read_b64_tr_b16 v[46:47], v219 offset:1024
v_mfma_f32_16x16x32_bf16 v[88:91], v[204:207], v[48:51], v[88:91]
v_add_u32 v215, s93, v225
v_mfma_f32_16x16x32_bf16 v[92:95], v[204:207], v[52:55], v[92:95]
s_waitcnt lgkmcnt(0)
v_mfma_f32_16x16x32_bf16 v[64:67], v[32:35], v[16:19], v[64:67]
ds_read_b128 v[48:51], v215 offset:0
ds_read_b64_tr_b16 v[192:193], v216 offset:8192
v_mfma_f32_16x16x32_bf16 v[68:71], v[32:35], v[20:23], v[68:71]
ds_read_b64_tr_b16 v[194:195], v216 offset:9216
ds_read_b128 v[52:55], v215 offset:2048
v_mfma_f32_16x16x32_bf16 v[72:75], v[36:39], v[16:19], v[72:75]
ds_read_b64_tr_b16 v[196:197], v217 offset:8192
ds_read_b64_tr_b16 v[198:199], v217 offset:9216
v_mfma_f32_16x16x32_bf16 v[76:79], v[36:39], v[20:23], v[76:79]
ds_read_b64_tr_b16 v[200:201], v218 offset:8192
ds_read_b64_tr_b16 v[202:203], v218 offset:9216
v_mfma_f32_16x16x32_bf16 v[80:83], v[40:43], v[16:19], v[80:83]
ds_read_b64_tr_b16 v[204:205], v219 offset:8192
ds_read_b64_tr_b16 v[206:207], v219 offset:9216
v_mfma_f32_16x16x32_bf16 v[84:87], v[40:43], v[20:23], v[84:87]
s_add_u32 s93, s93, 32768
s_cmp_eq_u32 s93, 163840
v_mfma_f32_16x16x32_bf16 v[88:91], v[44:47], v[16:19], v[88:91]
s_cselect_b32 s93, 0, s93
v_add_u32 v214, s93, v224
v_mfma_f32_16x16x32_bf16 v[92:95], v[44:47], v[20:23], v[92:95]
s_waitcnt lgkmcnt(0)
s_barrier
v_mfma_f32_16x16x32_bf16 v[64:67], v[192:195], v[48:51], v[64:67]
v_add_u32 v216, s93, v210
v_add_u32 v217, s93, v211
v_add_u32 v218, s93, v212
v_add_u32 v219, s93, v213
v_mfma_f32_16x16x32_bf16 v[68:71], v[192:195], v[52:55], v[68:71]
ds_read_b128 v[16:19], v214 offset:0
ds_read_b64_tr_b16 v[32:33], v216 offset:0
v_mfma_f32_16x16x32_bf16 v[72:75], v[196:199], v[48:51], v[72:75]
ds_read_b64_tr_b16 v[34:35], v216 offset:1024
ds_read_b128 v[20:23], v214 offset:2048
v_mfma_f32_16x16x32_bf16 v[76:79], v[196:199], v[52:55], v[76:79]
ds_read_b64_tr_b16 v[36:37], v217 offset:0
ds_read_b64_tr_b16 v[38:39], v217 offset:1024
v_mfma_f32_16x16x32_bf16 v[80:83], v[200:203], v[48:51], v[80:83]
ds_read_b64_tr_b16 v[40:41], v218 offset:0
ds_read_b64_tr_b16 v[42:43], v218 offset:1024
v_mfma_f32_16x16x32_bf16 v[84:87], v[200:203], v[52:55], v[84:87]
ds_read_b64_tr_b16 v[44:45], v219 offset:0
ds_read_b64_tr_b16 v[46:47], v219 offset:1024
v_mfma_f32_16x16x32_bf16 v[88:91], v[204:207], v[48:51], v[88:91]
v_add_u32 v215, s93, v225
v_mfma_f32_16x16x32_bf16 v[92:95], v[204:207], v[52:55], v[92:95]
s_waitcnt lgkmcnt(0)
v_mfma_f32_16x16x32_bf16 v[64:67], v[32:35], v[16:19], v[64:67]
ds_read_b128 v[48:51], v215 offset:0
ds_read_b64_tr_b16 v[192:193], v216 offset:8192
v_mfma_f32_16x16x32_bf16 v[68:71], v[32:35], v[20:23], v[68:71]
ds_read_b64_tr_b16 v[194:195], v216 offset:9216
ds_read_b128 v[52:55], v215 offset:2048
v_mfma_f32_16x16x32_bf16 v[72:75], v[36:39], v[16:19], v[72:75]
ds_read_b64_tr_b16 v[196:197], v217 offset:8192
ds_read_b64_tr_b16 v[198:199], v217 offset:9216
v_mfma_f32_16x16x32_bf16 v[76:79], v[36:39], v[20:23], v[76:79]
ds_read_b64_tr_b16 v[200:201], v218 offset:8192
ds_read_b64_tr_b16 v[202:203], v218 offset:9216
v_mfma_f32_16x16x32_bf16 v[80:83], v[40:43], v[16:19], v[80:83]
ds_read_b64_tr_b16 v[204:205], v219 offset:8192
ds_read_b64_tr_b16 v[206:207], v219 offset:9216
v_mfma_f32_16x16x32_bf16 v[84:87], v[40:43], v[20:23], v[84:87]
s_add_u32 s93, s93, 32768
s_cmp_eq_u32 s93, 163840
v_mfma_f32_16x16x32_bf16 v[88:91], v[44:47], v[16:19], v[88:91]
s_cselect_b32 s93, 0, s93
v_add_u32 v214, s93, v224
v_mfma_f32_16x16x32_bf16 v[92:95], v[44:47], v[20:23], v[92:95]
s_waitcnt lgkmcnt(0)
s_barrier
v_mfma_f32_16x16x32_bf16 v[64:67], v[192:195], v[48:51], v[64:67]
v_add_u32 v216, s93, v210
v_add_u32 v217, s93, v211
v_add_u32 v218, s93, v212
v_add_u32 v219, s93, v213
v_mfma_f32_16x16x32_bf16 v[68:71], v[192:195], v[52:55], v[68:71]
v_add_u32 v215, s93, v225
v_mfma_f32_16x16x32_bf16 v[72:75], v[196:199], v[48:51], v[72:75]
v_mfma_f32_16x16x32_bf16 v[76:79], v[196:199], v[52:55], v[76:79]
v_mfma_f32_16x16x32_bf16 v[80:83], v[200:203], v[48:51], v[80:83]
v_mfma_f32_16x16x32_bf16 v[84:87], v[200:203], v[52:55], v[84:87]
v_mfma_f32_16x16x32_bf16 v[88:91], v[204:207], v[48:51], v[88:91]
v_mfma_f32_16x16x32_bf16 v[92:95], v[204:207], v[52:55], v[92:95]
s_waitcnt lgkmcnt(0)
s_mov_b32 s34, 0
L_g2_poll:
buffer_load_dwordx4 v[96:99], v5, s[52:55], s33 offen offset:0 sc1
buffer_load_dwordx4 v[100:103], v5, s[52:55], s33 offen offset:1024 sc1
buffer_load_dwordx4 v[104:107], v5, s[52:55], s33 offen offset:2048 sc1
buffer_load_dwordx4 v[108:111], v5, s[52:55], s33 offen offset:3072 sc1
s_cmp_lg_u32 s34, 0
s_cbranch_scc1 L_g2_pw
v_mul_f32 v128, v128, v8
v_fmac_f32 v128, v64, v220
v_mul_f32 v129, v129, v8
v_fmac_f32 v129, v65, v220
v_mul_f32 v130, v130, v8
v_fmac_f32 v130, v66, v220
v_mul_f32 v131, v131, v8
v_fmac_f32 v131, v67, v220
v_mul_f32 v132, v132, v9
v_fmac_f32 v132, v68, v221
v_mul_f32 v133, v133, v9
v_fmac_f32 v133, v69, v221
v_mul_f32 v134, v134, v9
v_fmac_f32 v134, v70, v221
v_mul_f32 v135, v135, v9
v_fmac_f32 v135, v71, v221
v_mul_f32 v144, v144, v8
v_fmac_f32 v144, v72, v220
v_mul_f32 v145, v145, v8
v_fmac_f32 v145, v73, v220
v_mul_f32 v146, v146, v8
v_fmac_f32 v146, v74, v220
v_mul_f32 v147, v147, v8
v_fmac_f32 v147, v75, v220
v_mul_f32 v148, v148, v9
v_fmac_f32 v148, v76, v221
v_mul_f32 v149, v149, v9
v_fmac_f32 v149, v77, v221
v_mul_f32 v150, v150, v9
v_fmac_f32 v150, v78, v221
v_mul_f32 v151, v151, v9
v_fmac_f32 v151, v79, v221
v_mul_f32 v160, v160, v8
v_fmac_f32 v160, v80, v220
v_mul_f32 v161, v161, v8
v_fmac_f32 v161, v81, v220
v_mul_f32 v162, v162, v8
v_fmac_f32 v162, v82, v220
v_mul_f32 v163, v163, v8
v_fmac_f32 v163, v83, v220
v_mul_f32 v164, v164, v9
v_fmac_f32 v164, v84, v221
v_mul_f32 v165, v165, v9
v_fmac_f32 v165, v85, v221
v_mul_f32 v166, v166, v9
v_fmac_f32 v166, v86, v221
v_mul_f32 v167, v167, v9
v_fmac_f32 v167, v87, v221
v_mul_f32 v176, v176, v8
v_fmac_f32 v176, v88, v220
v_mul_f32 v177, v177, v8
v_fmac_f32 v177, v89, v220
v_mul_f32 v178, v178, v8
v_fmac_f32 v178, v90, v220
v_mul_f32 v179, v179, v8
v_fmac_f32 v179, v91, v220
v_mul_f32 v180, v180, v9
v_fmac_f32 v180, v92, v221
v_mul_f32 v181, v181, v9
v_fmac_f32 v181, v93, v221
v_mul_f32 v182, v182, v9
v_fmac_f32 v182, v94, v221
v_mul_f32 v183, v183, v9
v_fmac_f32 v183, v95, v221
s_lshl_b32 s30, s26, 6
s_lshl_b32 s31, s86, 5
s_add_u32 s30, s30, s31
v_add_u32 v6, s30, v3
v_lshlrev_b32 v6, 4, v6
v_add_u32 v6, s22, v6
v_lshlrev_b32 v6, 11, v6
s_lshl_b32 s30, s85, 8
s_lshl_b32 s31, s27, 7
s_add_u32 s30, s30, s31
v_add_u32 v6, s30, v6
v_and_b32 v7, 1, v4
v_lshlrev_b32 v7, 5, v7
v_add_u32 v6, v6, v7
v_lshrrev_b32 v7, 1, v4
v_lshlrev_b32 v7, 4, v7
v_add_u32 v6, v6, v7
L_g2_pw:
s_waitcnt vmcnt(0)
v_max3_u32 v7, v96, v97, v98
v_max3_u32 v7, v7, v99, v100
v_max3_u32 v7, v7, v101, v102
v_max3_u32 v7, v7, v103, v104
v_max3_u32 v7, v7, v105, v106
v_max3_u32 v7, v7, v107, v108
v_max3_u32 v7, v7, v109, v110
v_max_u32 v7, v7, v111
v_cmp_eq_u32 vcc, -1, v7
s_add_u32 s34, s34, 1
s_cmp_lt_u32 s34, 131072
s_cselect_b64 s[30:31], -1, 0
s_and_b64 vcc, vcc, s[30:31]
s_cbranch_vccnz L_g2_poll
v_lshlrev_b32 v112, 16, v96
v_and_b32 v113, 0xffff0000, v96
v_add_f32 v128, v128, v112
v_add_f32 v129, v129, v113
v_lshlrev_b32 v112, 16, v97
v_and_b32 v113, 0xffff0000, v97
v_add_f32 v130, v130, v112
v_add_f32 v131, v131, v113
v_lshlrev_b32 v112, 16, v98
v_and_b32 v113, 0xffff0000, v98
v_add_f32 v132, v132, v112
v_add_f32 v133, v133, v113
v_lshlrev_b32 v112, 16, v99
v_and_b32 v113, 0xffff0000, v99
v_add_f32 v134, v134, v112
v_add_f32 v135, v135, v113
v_lshlrev_b32 v112, 16, v100
v_and_b32 v113, 0xffff0000, v100
v_add_f32 v144, v144, v112
v_add_f32 v145, v145, v113
v_lshlrev_b32 v112, 16, v101
v_and_b32 v113, 0xffff0000, v101
v_add_f32 v146, v146, v112
v_add_f32 v147, v147, v113
v_lshlrev_b32 v112, 16, v102
v_and_b32 v113, 0xffff0000, v102
v_add_f32 v148, v148, v112
v_add_f32 v149, v149, v113
v_lshlrev_b32 v112, 16, v103
v_and_b32 v113, 0xffff0000, v103
v_add_f32 v150, v150, v112
v_add_f32 v151, v151, v113
v_lshlrev_b32 v112, 16, v104
v_and_b32 v113, 0xffff0000, v104
v_add_f32 v160, v160, v112
v_add_f32 v161, v161, v113
v_lshlrev_b32 v112, 16, v105
v_and_b32 v113, 0xffff0000, v105
v_add_f32 v162, v162, v112
v_add_f32 v163, v163, v113
v_lshlrev_b32 v112, 16, v106
v_and_b32 v113, 0xffff0000, v106
v_add_f32 v164, v164, v112
v_add_f32 v165, v165, v113
v_lshlrev_b32 v112, 16, v107
v_and_b32 v113, 0xffff0000, v107
v_add_f32 v166, v166, v112
v_add_f32 v167, v167, v113
v_lshlrev_b32 v112, 16, v108
v_and_b32 v113, 0xffff0000, v108
v_add_f32 v176, v176, v112
v_add_f32 v177, v177, v113
v_lshlrev_b32 v112, 16, v109
v_and_b32 v113, 0xffff0000, v109
v_add_f32 v178, v178, v112
v_add_f32 v179, v179, v113
v_lshlrev_b32 v112, 16, v110
v_and_b32 v113, 0xffff0000, v110
v_add_f32 v180, v180, v112
v_add_f32 v181, v181, v113
v_lshlrev_b32 v112, 16, v111
v_and_b32 v113, 0xffff0000, v111
v_add_f32 v182, v182, v112
v_add_f32 v183, v183, v113
v_cvt_pk_bf16_f32 v16, v128, v129
v_cvt_pk_bf16_f32 v17, v130, v131
v_cvt_pk_bf16_f32 v18, v144, v145
v_cvt_pk_bf16_f32 v19, v146, v147
v_cvt_pk_bf16_f32 v20, v160, v161
v_cvt_pk_bf16_f32 v21, v162, v163
v_cvt_pk_bf16_f32 v22, v176, v177
v_cvt_pk_bf16_f32 v23, v178, v179
v_cvt_pk_bf16_f32 v24, v132, v133
v_cvt_pk_bf16_f32 v25, v134, v135
v_cvt_pk_bf16_f32 v26, v148, v149
v_cvt_pk_bf16_f32 v27, v150, v151
v_cvt_pk_bf16_f32 v28, v164, v165
v_cvt_pk_bf16_f32 v29, v166, v167
v_cvt_pk_bf16_f32 v30, v180, v181
v_cvt_pk_bf16_f32 v31, v182, v183
s_nop 1
v_permlane16_swap_b32 v16, v18
v_permlane16_swap_b32 v17, v19
v_permlane16_swap_b32 v20, v22
v_permlane16_swap_b32 v21, v23
v_permlane16_swap_b32 v24, v26
v_permlane16_swap_b32 v25, v27
v_permlane16_swap_b32 v28, v30
v_permlane16_swap_b32 v29, v31
s_nop 1
s_mov_b32 s30, 524288
buffer_store_dwordx4 v[16:19], v6, s[80:83], 0 offen offset:0 nt
buffer_store_dwordx4 v[20:23], v6, s[80:83], 0 offen offset:64 nt
buffer_store_dwordx4 v[24:27], v6, s[80:83], s30 offen offset:0 nt
buffer_store_dwordx4 v[28:31], v6, s[80:83], s30 offen offset:64 nt
s_branch L_fin
L_stage_g1:
s_cmp_eq_u32 s95, 1
s_cbranch_scc0 L_s2done
s_mov_b32 m0, s97
s_nop 0
buffer_load_dwordx4 v194, s[40:43], s96 offen offset:2048 lds
buffer_load_dwordx4 v195, s[40:43], s96 offen offset:3072 lds
s_add_u32 m0, m0, 4096
s_nop 0
buffer_load_dwordx4 v196, s[40:43], s96 offen offset:0 lds
buffer_load_dwordx4 v197, s[40:43], s96 offen offset:1024 lds
L_s2done:
s_waitcnt vmcnt(49)
s_barrier
s_waitcnt vmcnt(27)
s_barrier
s_add_u32 m0, s91, s87
s_nop 0
buffer_load_dwordx4 v176, s[36:39], s89 offen offset:0 lds
buffer_load_dwordx4 v177, s[36:39], s89 offen offset:1024 lds
buffer_load_dwordx4 v178, s[36:39], s89 offen offset:2048 lds
buffer_load_dwordx4 v179, s[36:39], s89 offen offset:3072 lds
s_add_u32 m0, m0, 4096
s_nop 0
buffer_load_dwordx4 v180, s[36:39], s89 offen offset:0 lds
buffer_load_dwordx4 v181, s[36:39], s89 offen offset:1024 lds
buffer_load_dwordx4 v182, s[36:39], s89 offen offset:2048 lds
buffer_load_dwordx4 v183, s[36:39], s89 offen offset:3072 lds
s_add_u32 m0, s91, s88
s_nop 0
buffer_load_dwordx4 v184, s[40:43], s90 offen offset:0 lds
buffer_load_dwordx4 v185, s[40:43], s90 offen offset:1024 lds
buffer_load_dwordx4 v186, s[40:43], s90 offen offset:2048 lds
buffer_load_dwordx4 v187, s[40:43], s90 offen offset:3072 lds
s_add_u32 m0, m0, 4096
s_nop 0
buffer_load_dwordx4 v188, s[40:43], s90 offen offset:0 lds
buffer_load_dwordx4 v189, s[40:43], s90 offen offset:1024 lds
buffer_load_dwordx4 v190, s[40:43], s90 offen offset:2048 lds
buffer_load_dwordx4 v191, s[40:43], s90 offen offset:3072 lds
s_add_u32 m0, m0, 4096
s_nop 0
buffer_load_dwordx4 v192, s[40:43], s90 offen offset:0 lds
buffer_load_dwordx4 v193, s[40:43], s90 offen offset:1024 lds
buffer_load_dwordx4 v194, s[40:43], s90 offen offset:2048 lds
buffer_load_dwordx4 v195, s[40:43], s90 offen offset:3072 lds
s_add_u32 m0, m0, 4096
s_nop 0
buffer_load_dwordx4 v196, s[40:43], s90 offen offset:0 lds
buffer_load_dwordx4 v197, s[40:43], s90 offen offset:1024 lds
s_add_u32 s89, s89, 128
s_add_u32 s90, s90, 458752
s_add_u32 s91, s91, 45056
s_cmp_eq_u32 s91, 135168
s_cselect_b32 s91, 0, s91
s_mov_b32 s92, 1
L_g1lloop:
s_waitcnt vmcnt(22)
s_barrier
s_add_u32 m0, s91, s87
s_nop 0
buffer_load_dwordx4 v176, s[36:39], s89 offen offset:0 lds
buffer_load_dwordx4 v177, s[36:39], s89 offen offset:1024 lds
buffer_load_dwordx4 v178, s[36:39], s89 offen offset:2048 lds
buffer_load_dwordx4 v179, s[36:39], s89 offen offset:3072 lds
s_add_u32 m0, m0, 4096
s_nop 0
buffer_load_dwordx4 v180, s[36:39], s89 offen offset:0 lds
buffer_load_dwordx4 v181, s[36:39], s89 offen offset:1024 lds
buffer_load_dwordx4 v182, s[36:39], s89 offen offset:2048 lds
buffer_load_dwordx4 v183, s[36:39], s89 offen offset:3072 lds
s_add_u32 m0, s91, s88
s_nop 0
buffer_load_dwordx4 v184, s[40:43], s90 offen offset:0 lds
buffer_load_dwordx4 v185, s[40:43], s90 offen offset:1024 lds
buffer_load_dwordx4 v186, s[40:43], s90 offen offset:2048 lds
buffer_load_dwordx4 v187, s[40:43], s90 offen offset:3072 lds
s_add_u32 m0, m0, 4096
s_nop 0
buffer_load_dwordx4 v188, s[40:43], s90 offen offset:0 lds
buffer_load_dwordx4 v189, s[40:43], s90 offen offset:1024 lds
buffer_load_dwordx4 v190, s[40:43], s90 offen offset:2048 lds
buffer_load_dwordx4 v191, s[40:43], s90 offen offset:3072 lds
s_add_u32 m0, m0, 4096
s_nop 0
buffer_load_dwordx4 v192, s[40:43], s90 offen offset:0 lds
buffer_load_dwordx4 v193, s[40:43], s90 offen offset:1024 lds
buffer_load_dwordx4 v194, s[40:43], s90 offen offset:2048 lds
buffer_load_dwordx4 v195, s[40:43], s90 offen offset:3072 lds
s_add_u32 m0, m0, 4096
s_nop 0
buffer_load_dwordx4 v196, s[40:43], s90 offen offset:0 lds
buffer_load_dwordx4 v197, s[40:43], s90 offen offset:1024 lds
s_add_u32 s89, s89, 128
s_add_u32 s90, s90, 458752
s_add_u32 s91, s91, 45056
s_cmp_eq_u32 s91, 135168
s_cselect_b32 s91, 0, s91
s_add_u32 s92, s92, 1
s_cmp_lt_u32 s92, 13
s_cbranch_scc1 L_g1lloop
s_waitcnt vmcnt(22)
s_barrier
s_waitcnt vmcnt(0)
s_barrier
s_barrier
s_branch L_lsetup
L_help_g1:
s_add_u32 s52, s8, 0x2000000
s_addc_u32 s53, s9, 0
s_mov_b32 s54, 0x400000
s_mov_b32 s55, 0x20000
s_mov_b32 s64, s10
s_mov_b32 s65, s11
s_mov_b32 s66, 0x700000
s_mov_b32 s67, 0x20000
s_sub_u32 s35, s95, 2
s_lshl_b32 s30, s22, 3
s_add_u32 s30, s30, s85
s_lshl_b32 s30, s30, 1
s_add_u32 s30, s30, s86
s_lshl_b32 s30, s30, 14
s_lshl_b32 s31, s35, 13
s_add_u32 s82, s30, s31
v_mov_b32 v8, -1
v_mov_b32 v9, -1
v_mov_b32 v10, -1
v_mov_b32 v11, -1
s_barrier
s_mov_b32 s92, 0
L_tloop:
s_barrier
s_cmp_eq_u32 s92, 2
s_cbranch_scc0 L_noinit
s_cmp_eq_u32 s24, 1
s_cbranch_scc0 L_noinit
s_waitcnt vmcnt(24)
v_mov_b32 v12, 1
v_mov_b32 v13, 0
s_mov_b64 exec, 1
buffer_atomic_add v12, v13, s[76:79], 0 offen sc1
s_mov_b64 exec, -1
L_noinit:
s_cmp_lt_u32 s92, 8
s_cbranch_scc0 L_t1
buffer_store_dwordx4 v[8:11], v200, s[52:55], s82 offen sc1
s_add_u32 s82, s82, 1024
L_t1:
s_add_u32 s92, s92, 1
s_cmp_lt_u32 s92, 13
s_cbranch_scc1 L_tloop
s_barrier
s_mul_i32 s31, s2, 28672
s_mul_i32 s32, s35, 14336
s_add_u32 s31, s31, s32
buffer_load_dwordx4 v[244:247], v200, s[64:67], s31 offen offset:0
buffer_load_dwordx4 v[244:247], v200, s[64:67], s31 offen offset:1024
buffer_load_dwordx4 v[244:247], v200, s[64:67], s31 offen offset:2048
buffer_load_dwordx4 v[244:247], v200, s[64:67], s31 offen offset:3072
s_add_u32 s31, s31, 4096
buffer_load_dwordx4 v[244:247], v200, s[64:67], s31 offen offset:0
buffer_load_dwordx4 v[244:247], v200, s[64:67], s31 offen offset:1024
buffer_load_dwordx4 v[244:247], v200, s[64:67], s31 offen offset:2048
buffer_load_dwordx4 v[244:247], v200, s[64:67], s31 offen offset:3072
s_add_u32 s31, s31, 4096
buffer_load_dwordx4 v[244:247], v200, s[64:67], s31 offen offset:0
buffer_load_dwordx4 v[244:247], v200, s[64:67], s31 offen offset:1024
buffer_load_dwordx4 v[244:247], v200, s[64:67], s31 offen offset:2048
buffer_load_dwordx4 v[244:247], v200, s[64:67], s31 offen offset:3072
s_add_u32 s31, s31, 4096
buffer_load_dwordx4 v[244:247], v200, s[64:67], s31 offen offset:0
buffer_load_dwordx4 v[244:247], v200, s[64:67], s31 offen offset:1024
s_mov_b32 s68, s16
s_mov_b32 s69, s17
s_mov_b32 s70, 0x200000
s_mov_b32 s71, 0x20000
s_mov_b32 s72, s18
s_mov_b32 s73, s19
s_mov_b32 s74, 0x200000
s_mov_b32 s75, 0x20000
s_and_b32 s31, s2, 127
s_lshl_b32 s31, s31, 14
v_lshlrev_b32 v5, 2, v1
buffer_load_dword v244, v5, s[68:71], s31 offen
buffer_load_dword v244, v5, s[72:75], s31 offen
s_barrier
s_cmp_eq_u32 s101, 1
s_cbranch_scc0 L_norows
s_sub_u32 s35, s95, 2
s_lshl_b32 s31, s35, 3
s_lshl_b32 s32, s31, 7
s_add_u32 s32, s32, s28
s_lshl_b32 s32, s32, 11
s_lshl_b32 s33, s31, 11
s_add_u32 s33, s33, 131072
s_add_u32 m0, s33, 0
s_add_u32 s34, s32, 0
buffer_load_dwordx4 v198, s[36:39], s34 offen lds
s_add_u32 m0, s33, 1024
s_add_u32 s34, s32, 1024
buffer_load_dwordx4 v198, s[36:39], s34 offen lds
s_add_u32 m0, s33, 2048
s_add_u32 s34, s32, 262144
buffer_load_dwordx4 v198, s[36:39], s34 offen lds
s_add_u32 m0, s33, 3072
s_add_u32 s34, s32, 263168
buffer_load_dwordx4 v198, s[36:39], s34 offen lds
s_add_u32 m0, s33, 4096
s_add_u32 s34, s32, 524288
buffer_load_dwordx4 v198, s[36:39], s34 offen lds
s_add_u32 m0, s33, 5120
s_add_u32 s34, s32, 525312
buffer_load_dwordx4 v198, s[36:39], s34 offen lds
s_add_u32 m0, s33, 6144
s_add_u32 s34, s32, 786432
buffer_load_dwordx4 v198, s[36:39], s34 offen lds
s_add_u32 m0, s33, 7168
s_add_u32 s34, s32, 787456
buffer_load_dwordx4 v198, s[36:39], s34 offen lds
s_add_u32 m0, s33, 8192
s_add_u32 s34, s32, 1048576
buffer_load_dwordx4 v198, s[36:39], s34 offen lds
s_add_u32 m0, s33, 9216
s_add_u32 s34, s32, 1049600
buffer_load_dwordx4 v198, s[36:39], s34 offen lds
s_add_u32 m0, s33, 10240
s_add_u32 s34, s32, 1310720
buffer_load_dwordx4 v198, s[36:39], s34 offen lds
s_add_u32 m0, s33, 11264
s_add_u32 s34, s32, 1311744
buffer_load_dwordx4 v198, s[36:39], s34 offen lds
s_add_u32 m0, s33, 12288
s_add_u32 s34, s32, 1572864
buffer_load_dwordx4 v198, s[36:39], s34 offen lds
s_add_u32 m0, s33, 13312
s_add_u32 s34, s32, 1573888
buffer_load_dwordx4 v198, s[36:39], s34 offen lds
s_add_u32 m0, s33, 14336
s_add_u32 s34, s32, 1835008
buffer_load_dwordx4 v198, s[36:39], s34 offen lds
s_add_u32 m0, s33, 15360
s_add_u32 s34, s32, 1836032
buffer_load_dwordx4 v198, s[36:39], s34 offen lds
L_norows:
s_barrier
L_lsetup:
s_mov_b32 s64, s10
s_mov_b32 s65, s11
s_mov_b32 s66, 0x700000
s_mov_b32 s67, 0x20000
s_lshl_b32 s31, s95, 4
v_add_u32 v5, s31, v4
v_lshlrev_b32 v5, 11, v5
s_lshl_b32 s31, s85, 8
s_mul_i32 s32, s86, 3670016
s_add_u32 s31, s31, s32
v_or_b32 v6, 0, v4
v_lshlrev_b32 v6, 1, v6
v_xor_b32 v6, v6, v3
v_lshl_add_u32 v7, v6, 4, v5
v_add_u32 v7, s31, v7
v_add_u32 v216, 0, v7
v_or_b32 v6, 0, v4
v_lshlrev_b32 v6, 1, v6
v_xor_b32 v6, v6, v3
v_lshl_add_u32 v7, v6, 4, v5
v_add_u32 v7, s31, v7
v_add_u32 v217, 7168, v7
v_or_b32 v6, 4, v4
v_lshlrev_b32 v6, 1, v6
v_xor_b32 v6, v6, v3
v_lshl_add_u32 v7, v6, 4, v5
v_add_u32 v7, s31, v7
v_add_u32 v218, 14336, v7
v_or_b32 v6, 4, v4
v_lshlrev_b32 v6, 1, v6
v_xor_b32 v6, v6, v3
v_lshl_add_u32 v7, v6, 4, v5
v_add_u32 v7, s31, v7
v_add_u32 v219, 21504, v7
s_and_b32 s30, s23, 7
s_lshr_b32 s31, s30, 1
s_and_b32 s30, s30, 1
s_lshl_b32 s30, s30, 2
s_mul_i32 s84, s31, 7
s_add_u32 s84, s84, s30
s_mul_i32 s24, s86, 458752
v_subrev_u32 v5, 3, v1
v_cmp_le_u32 vcc, s84, v5
v_add_u32 v6, 3, v5
v_add_u32 v7, s84, v1
v_cndmask_b32 v5, v5, v6, vcc
v_cmp_gt_u32 vcc, 3, v1
s_nop 1
v_cndmask_b32 v5, v5, v7, vcc
v_lshlrev_b32 v207, 17, v5
v_mul_u32_u24 v6, 37, v5
v_lshrrev_b32 v6, 8, v6
v_mul_u32_u24 v6, 57344, v6
v_lshl_add_u32 v6, v5, 13, v6
v_add_u32 v206, s24, v6
v_mul_u32_u24 v6, 52, v1
v_lshrrev_b32 v6, 8, v6
v_mul_u32_u24 v6, 5, v6
v_sub_u32 v6, v1, v6
v_lshlrev_b32 v208, 15, v6
s_lshl_b32 s87, s95, 12
s_add_u32 s88, s87, 16384
v_readlane_b32 s30, v208, 0
v_readlane_b32 s90, v207, 0
s_nop 0
s_add_u32 s81, s30, s88
s_nop 2
s_mov_b32 m0, s81
s_nop 0
buffer_load_dwordx4 v216, s[64:67], s90 offen offset:0 lds
buffer_load_dwordx4 v217, s[64:67], s90 offen offset:1024 lds
buffer_load_dwordx4 v218, s[64:67], s90 offen offset:2048 lds
buffer_load_dwordx4 v219, s[64:67], s90 offen offset:3072 lds
v_readlane_b32 s30, v208, 1
v_readlane_b32 s90, v207, 1
s_nop 0
s_add_u32 s81, s30, s88
s_nop 2
s_mov_b32 m0, s81
s_nop 0
buffer_load_dwordx4 v216, s[64:67], s90 offen offset:0 lds
buffer_load_dwordx4 v217, s[64:67], s90 offen offset:1024 lds
buffer_load_dwordx4 v218, s[64:67], s90 offen offset:2048 lds
buffer_load_dwordx4 v219, s[64:67], s90 offen offset:3072 lds
v_readlane_b32 s30, v208, 2
v_readlane_b32 s90, v207, 2
s_nop 0
s_add_u32 s81, s30, s88
s_nop 2
s_mov_b32 m0, s81
s_nop 0
buffer_load_dwordx4 v216, s[64:67], s90 offen offset:0 lds
buffer_load_dwordx4 v217, s[64:67], s90 offen offset:1024 lds
buffer_load_dwordx4 v218, s[64:67], s90 offen offset:2048 lds
buffer_load_dwordx4 v219, s[64:67], s90 offen offset:3072 lds
s_cmp_eq_u32 s101, 0
s_cbranch_scc1 L_lsetup2
v_lshrrev_b32 v10, 1, v1
v_lshlrev_b32 v10, 6, v10
v_xor_b32 v11, v1, v4
v_and_b32 v11, 1, v11
v_lshl_add_u32 v10, v11, 5, v10
s_mov_b32 s60, s12
s_mov_b32 s61, s13
s_mov_b32 s62, 0x800
s_mov_b32 s63, 0x20000
buffer_load_dwordx4 v[232:235], v10, s[60:63], 0 offen
buffer_load_dwordx4 v[236:239], v10, s[60:63], 0 offen offset:16
s_branch L_fft
L_lsetup2:
s_add_u32 s48, s8, 0x1000000
s_addc_u32 s49, s9, 0
s_mov_b32 s50, 0x800000
s_mov_b32 s51, 0x20000
s_add_u32 s44, s8, 0xf000
s_addc_u32 s45, s9, 0
s_mov_b32 s46, 0xe01000
s_mov_b32 s47, 0x20000
s_mov_b32 s76, s98
s_mov_b32 s77, s99
s_mov_b32 s78, 0x100
s_mov_b32 s79, 0x20000
s_mov_b32 s68, s16
s_mov_b32 s69, s17
s_mov_b32 s70, 0x200000
s_mov_b32 s71, 0x20000
s_mov_b32 s72, s18
s_mov_b32 s73, s19
s_mov_b32 s74, 0x200000
s_mov_b32 s75, 0x20000
s_add_u32 s60, s8, 0x1900000
s_addc_u32 s61, s9, 0
s_mov_b32 s62, 0x2000
s_mov_b32 s63, 0x20000
s_mul_i32 s31, s22, 917504
s_lshr_b32 s32, s95, 1
s_mul_i32 s32, s32, 57344
s_add_u32 s31, s31, s32
s_and_b32 s32, s95, 1
s_lshl_b32 s32, s32, 9
s_add_u32 s31, s31, s32
s_add_u32 s31, s31, 4096
v_lshrrev_b32 v5, 3, v1
v_lshlrev_b32 v5, 10, v5
v_and_b32 v6, 7, v1
v_lshl_add_u32 v5, v6, 4, v5
v_add_u32 v5, s31, v5
v_add_u32 v212, 0, v5
v_add_u32 v213, -896, v5
v_add_u32 v214, -1792, v5
v_add_u32 v215, -2688, v5
v_and_b32 v6, 7, v1
v_xor_b32 v6, v6, v4
s_lshl_b32 s31, s95, 4
s_add_u32 s31, s31, 0
v_lshrrev_b32 v5, 3, v1
v_add_u32 v5, s31, v5
v_lshrrev_b32 v8, 5, v5
v_lshlrev_b32 v8, 6, v8
v_and_b32 v5, 31, v5
v_add_u32 v5, v5, v8
s_lshl_b32 s31, s86, 5
v_add_u32 v5, s31, v5
v_lshlrev_b32 v5, 14, v5
v_xor_b32 v9, 0, v6
v_lshlrev_b32 v9, 4, v9
v_add_u32 v5, v5, v9
v_subrev_u32 v220, 0, v5
s_lshl_b32 s31, s95, 4
s_add_u32 s31, s31, 8
v_lshrrev_b32 v5, 3, v1
v_add_u32 v5, s31, v5
v_lshrrev_b32 v8, 5, v5
v_lshlrev_b32 v8, 6, v8
v_and_b32 v5, 31, v5
v_add_u32 v5, v5, v8
s_lshl_b32 s31, s86, 5
v_add_u32 v5, s31, v5
v_lshlrev_b32 v5, 14, v5
v_xor_b32 v9, 4, v6
v_lshlrev_b32 v9, 4, v9
v_add_u32 v5, v5, v9
v_subrev_u32 v221, 1024, v5
s_lshl_b32 s31, s95, 4
v_add_u32 v5, s31, v4
v_lshlrev_b32 v9, 15, v5
s_lshl_b32 s33, s22, 6
s_lshl_b32 s34, s85, 11
s_add_u32 s33, s33, s34
v_or_b32 v6, 0, v4
v_lshlrev_b32 v6, 1, v6
v_xor_b32 v6, v6, v3
v_bfe_u32 v7, v6, 1, 1
v_lshlrev_b32 v7, 14, v7
v_lshrrev_b32 v8, 3, v6
v_lshl_add_u32 v7, v8, 10, v7
v_bfe_u32 v8, v6, 2, 1
v_lshl_add_u32 v7, v8, 5, v7
v_and_b32 v8, 1, v6
v_lshl_add_u32 v7, v8, 4, v7
v_add_u32 v7, v7, v9
v_add_u32 v7, s33, v7
v_add_u32 v222, 0, v7
v_or_b32 v6, 0, v4
v_lshlrev_b32 v6, 1, v6
v_xor_b32 v6, v6, v3
v_bfe_u32 v7, v6, 1, 1
v_lshlrev_b32 v7, 14, v7
v_lshrrev_b32 v8, 3, v6
v_lshl_add_u32 v7, v8, 10, v7
v_bfe_u32 v8, v6, 2, 1
v_lshl_add_u32 v7, v8, 5, v7
v_and_b32 v8, 1, v6
v_lshl_add_u32 v7, v8, 4, v7
v_add_u32 v7, v7, v9
v_add_u32 v7, s33, v7
v_add_u32 v223, 130048, v7
v_or_b32 v6, 4, v4
v_lshlrev_b32 v6, 1, v6
v_xor_b32 v6, v6, v3
v_bfe_u32 v7, v6, 1, 1
v_lshlrev_b32 v7, 14, v7
v_lshrrev_b32 v8, 3, v6
v_lshl_add_u32 v7, v8, 10, v7
v_bfe_u32 v8, v6, 2, 1
v_lshl_add_u32 v7, v8, 5, v7
v_and_b32 v8, 1, v6
v_lshl_add_u32 v7, v8, 4, v7
v_add_u32 v7, v7, v9
v_add_u32 v7, s33, v7
v_add_u32 v224, 260096, v7
v_or_b32 v6, 4, v4
v_lshlrev_b32 v6, 1, v6
v_xor_b32 v6, v6, v3
v_bfe_u32 v7, v6, 1, 1
v_lshlrev_b32 v7, 14, v7
v_lshrrev_b32 v8, 3, v6
v_lshl_add_u32 v7, v8, 10, v7
v_bfe_u32 v8, v6, 2, 1
v_lshl_add_u32 v7, v8, 5, v7
v_and_b32 v8, 1, v6
v_lshl_add_u32 v7, v8, 4, v7
v_add_u32 v7, v7, v9
v_add_u32 v7, s33, v7
v_add_u32 v225, 390144, v7
s_lshl_b32 s31, s22, 1
s_add_u32 s31, s31, s86
s_lshl_b32 s83, s31, 8
v_and_b32 v229, 31, v1
v_lshlrev_b32 v229, 2, v229
s_and_b32 s30, s23, 6
s_cmp_eq_u32 s30, 0
s_cbranch_scc1 L_bh_first
s_mov_b32 s34, 0
L_pe:
buffer_load_dword v230, v229, s[60:63], s83 offen sc1
s_waitcnt vmcnt(0)
v_cmp_eq_u32 vcc, 1, v230
s_nop 3
s_and_b32 s30, vcc_lo, 0xff
s_cmp_eq_u32 s30, 0xff
s_cbranch_scc1 L_pe_ok
s_add_u32 s34, s34, 1
s_cmp_lt_u32 s34, 131072
s_cbranch_scc0 L_pe_ok
s_branch L_pe
L_pe_ok:
v_readlane_b32 s30, v208, 3
v_readlane_b32 s89, v206, 3
v_readlane_b32 s90, v207, 3
s_nop 0
s_add_u32 s82, s30, s87
s_add_u32 s81, s30, s88
s_nop 2
s_mov_b32 m0, s82
s_nop 0
buffer_load_dwordx4 v212, s[44:47], s89 offen offset:0 lds
buffer_load_dwordx4 v213, s[44:47], s89 offen offset:1024 lds
buffer_load_dwordx4 v214, s[44:47], s89 offen offset:2048 lds
buffer_load_dwordx4 v215, s[44:47], s89 offen offset:3072 lds
s_mov_b32 m0, s81
s_nop 0
buffer_load_dwordx4 v216, s[64:67], s90 offen offset:0 lds
buffer_load_dwordx4 v217, s[64:67], s90 offen offset:1024 lds
buffer_load_dwordx4 v218, s[64:67], s90 offen offset:2048 lds
buffer_load_dwordx4 v219, s[64:67], s90 offen offset:3072 lds
v_readlane_b32 s30, v208, 4
v_readlane_b32 s89, v206, 4
v_readlane_b32 s90, v207, 4
s_nop 0
s_add_u32 s82, s30, s87
s_add_u32 s81, s30, s88
s_nop 2
s_mov_b32 m0, s82
s_nop 0
buffer_load_dwordx4 v212, s[44:47], s89 offen offset:0 lds
buffer_load_dwordx4 v213, s[44:47], s89 offen offset:1024 lds
buffer_load_dwordx4 v214, s[44:47], s89 offen offset:2048 lds
buffer_load_dwordx4 v215, s[44:47], s89 offen offset:3072 lds
s_mov_b32 m0, s81
s_nop 0
buffer_load_dwordx4 v216, s[64:67], s90 offen offset:0 lds
buffer_load_dwordx4 v217, s[64:67], s90 offen offset:1024 lds
buffer_load_dwordx4 v218, s[64:67], s90 offen offset:2048 lds
buffer_load_dwordx4 v219, s[64:67], s90 offen offset:3072 lds
s_barrier
s_barrier
s_barrier
s_branch L_bh_join
L_bh_first:
s_barrier
s_barrier
s_barrier
s_mov_b32 s34, 0
L_p0:
buffer_load_dword v230, v229, s[60:63], s83 offen sc1
s_waitcnt vmcnt(0)
v_cmp_eq_u32 vcc, 1, v230
s_nop 3
s_and_b32 s30, vcc_lo, 0xff
s_cmp_eq_u32 s30, 0xff
s_cbranch_scc1 L_p0_ok
s_add_u32 s34, s34, 1
s_cmp_lt_u32 s34, 131072
s_cbranch_scc0 L_p0_ok
s_branch L_p0
L_p0_ok:
v_readlane_b32 s30, v208, 3
v_readlane_b32 s89, v206, 3
v_readlane_b32 s90, v207, 3
s_nop 0
s_add_u32 s82, s30, s87
s_add_u32 s81, s30, s88
s_nop 2
s_mov_b32 m0, s82
s_nop 0
buffer_load_dwordx4 v212, s[44:47], s89 offen offset:0 lds
buffer_load_dwordx4 v213, s[44:47], s89 offen offset:1024 lds
buffer_load_dwordx4 v214, s[44:47], s89 offen offset:2048 lds
buffer_load_dwordx4 v215, s[44:47], s89 offen offset:3072 lds
s_mov_b32 m0, s81
s_nop 0
buffer_load_dwordx4 v216, s[64:67], s90 offen offset:0 lds
buffer_load_dwordx4 v217, s[64:67], s90 offen offset:1024 lds
buffer_load_dwordx4 v218, s[64:67], s90 offen offset:2048 lds
buffer_load_dwordx4 v219, s[64:67], s90 offen offset:3072 lds
v_readlane_b32 s30, v208, 4
v_readlane_b32 s89, v206, 4
v_readlane_b32 s90, v207, 4
s_nop 0
s_add_u32 s82, s30, s87
s_add_u32 s81, s30, s88
s_nop 2
s_mov_b32 m0, s82
s_nop 0
buffer_load_dwordx4 v212, s[44:47], s89 offen offset:0 lds
buffer_load_dwordx4 v213, s[44:47], s89 offen offset:1024 lds
buffer_load_dwordx4 v214, s[44:47], s89 offen offset:2048 lds
buffer_load_dwordx4 v215, s[44:47], s89 offen offset:3072 lds
s_mov_b32 m0, s81
s_nop 0
buffer_load_dwordx4 v216, s[64:67], s90 offen offset:0 lds
buffer_load_dwordx4 v217, s[64:67], s90 offen offset:1024 lds
buffer_load_dwordx4 v218, s[64:67], s90 offen offset:2048 lds
buffer_load_dwordx4 v219, s[64:67], s90 offen offset:3072 lds
L_bh_join:
v_readlane_b32 s30, v208, 5
v_readlane_b32 s89, v206, 5
v_readlane_b32 s90, v207, 5
s_nop 0
s_add_u32 s82, s30, s87
s_add_u32 s81, s30, s88
s_nop 2
s_mov_b32 m0, s82
s_nop 0
buffer_load_dwordx4 v212, s[44:47], s89 offen offset:0 lds
buffer_load_dwordx4 v213, s[44:47], s89 offen offset:1024 lds
buffer_load_dwordx4 v214, s[44:47], s89 offen offset:2048 lds
buffer_load_dwordx4 v215, s[44:47], s89 offen offset:3072 lds
s_mov_b32 m0, s81
s_nop 0
buffer_load_dwordx4 v216, s[64:67], s90 offen offset:0 lds
buffer_load_dwordx4 v217, s[64:67], s90 offen offset:1024 lds
buffer_load_dwordx4 v218, s[64:67], s90 offen offset:2048 lds
buffer_load_dwordx4 v219, s[64:67], s90 offen offset:3072 lds
v_readlane_b32 s30, v208, 6
v_readlane_b32 s89, v206, 6
v_readlane_b32 s90, v207, 6
s_nop 0
s_add_u32 s82, s30, s87
s_add_u32 s81, s30, s88
s_nop 2
s_mov_b32 m0, s82
s_nop 0
buffer_load_dwordx4 v212, s[44:47], s89 offen offset:0 lds
buffer_load_dwordx4 v213, s[44:47], s89 offen offset:1024 lds
buffer_load_dwordx4 v214, s[44:47], s89 offen offset:2048 lds
buffer_load_dwordx4 v215, s[44:47], s89 offen offset:3072 lds
s_mov_b32 m0, s81
s_nop 0
buffer_load_dwordx4 v216, s[64:67], s90 offen offset:0 lds
buffer_load_dwordx4 v217, s[64:67], s90 offen offset:1024 lds
buffer_load_dwordx4 v218, s[64:67], s90 offen offset:2048 lds
buffer_load_dwordx4 v219, s[64:67], s90 offen offset:3072 lds
s_waitcnt vmcnt(24)
s_barrier
s_and_b32 s30, s23, 6
s_cmp_eq_u32 s30, 0
s_cbranch_scc0 L_pla
s_mov_b32 s34, 0
L_pall:
buffer_load_dword v230, v229, s[60:63], s83 offen sc1
s_waitcnt vmcnt(0)
v_cmp_eq_u32 vcc, 1, v230
s_nop 3
s_and_b32 s30, vcc_lo, 0xffffffff
s_cmp_eq_u32 s30, 0xffffffff
s_cbranch_scc1 L_pall_ok
s_add_u32 s34, s34, 1
s_cmp_lt_u32 s34, 131072
s_cbranch_scc0 L_pall_ok
s_branch L_pall
L_pall_ok:
s_branch L_plb
L_pla:
buffer_load_dword v232, v229, s[60:63], s83 offen sc1
L_plb:
v_readlane_b32 s30, v208, 7
v_readlane_b32 s89, v206, 7
v_readlane_b32 s90, v207, 7
s_nop 0
s_add_u32 s82, s30, s87
s_add_u32 s81, s30, s88
s_nop 2
s_mov_b32 m0, s82
s_nop 0
buffer_load_dwordx4 v212, s[44:47], s89 offen offset:0 lds
buffer_load_dwordx4 v213, s[44:47], s89 offen offset:1024 lds
buffer_load_dwordx4 v214, s[44:47], s89 offen offset:2048 lds
buffer_load_dwordx4 v215, s[44:47], s89 offen offset:3072 lds
s_mov_b32 m0, s81
s_nop 0
buffer_load_dwordx4 v216, s[64:67], s90 offen offset:0 lds
buffer_load_dwordx4 v217, s[64:67], s90 offen offset:1024 lds
buffer_load_dwordx4 v218, s[64:67], s90 offen offset:2048 lds
buffer_load_dwordx4 v219, s[64:67], s90 offen offset:3072 lds
s_waitcnt vmcnt(25)
s_barrier
v_readlane_b32 s30, v208, 8
v_readlane_b32 s89, v206, 8
v_readlane_b32 s90, v207, 8
s_nop 0
s_add_u32 s82, s30, s87
s_add_u32 s81, s30, s88
s_nop 2
s_mov_b32 m0, s82
s_nop 0
buffer_load_dwordx4 v212, s[44:47], s89 offen offset:0 lds
buffer_load_dwordx4 v213, s[44:47], s89 offen offset:1024 lds
buffer_load_dwordx4 v214, s[44:47], s89 offen offset:2048 lds
buffer_load_dwordx4 v215, s[44:47], s89 offen offset:3072 lds
s_mov_b32 m0, s81
s_nop 0
buffer_load_dwordx4 v216, s[64:67], s90 offen offset:0 lds
buffer_load_dwordx4 v217, s[64:67], s90 offen offset:1024 lds
buffer_load_dwordx4 v218, s[64:67], s90 offen offset:2048 lds
buffer_load_dwordx4 v219, s[64:67], s90 offen offset:3072 lds
s_waitcnt vmcnt(25)
s_barrier
v_readlane_b32 s30, v208, 9
v_readlane_b32 s89, v206, 9
v_readlane_b32 s90, v207, 9
s_nop 0
s_add_u32 s82, s30, s87
s_add_u32 s81, s30, s88
s_nop 2
s_mov_b32 m0, s82
s_nop 0
buffer_load_dwordx4 v212, s[44:47], s89 offen offset:0 lds
buffer_load_dwordx4 v213, s[44:47], s89 offen offset:1024 lds
buffer_load_dwordx4 v214, s[44:47], s89 offen offset:2048 lds
buffer_load_dwordx4 v215, s[44:47], s89 offen offset:3072 lds
s_mov_b32 m0, s81
s_nop 0
buffer_load_dwordx4 v216, s[64:67], s90 offen offset:0 lds
buffer_load_dwordx4 v217, s[64:67], s90 offen offset:1024 lds
buffer_load_dwordx4 v218, s[64:67], s90 offen offset:2048 lds
buffer_load_dwordx4 v219, s[64:67], s90 offen offset:3072 lds
s_waitcnt vmcnt(25)
s_barrier
s_and_b32 s30, s23, 6
s_cmp_eq_u32 s30, 0
s_cbranch_scc1 L_pc_ok
s_waitcnt vmcnt(24)
v_cmp_eq_u32 vcc, 1, v232
s_nop 3
s_and_b32 s30, vcc_lo, 0xffffffff
s_cmp_eq_u32 s30, 0xffffffff
s_cbranch_scc1 L_pc_ok
s_mov_b32 s34, 0
L_pc2:
buffer_load_dword v230, v229, s[60:63], s83 offen sc1
s_waitcnt vmcnt(0)
v_cmp_eq_u32 vcc, 1, v230
s_nop 3
s_and_b32 s30, vcc_lo, 0xffffffff
s_cmp_eq_u32 s30, 0xffffffff
s_cbranch_scc1 L_pc2_ok
s_add_u32 s34, s34, 1
s_cmp_lt_u32 s34, 131072
s_cbranch_scc0 L_pc2_ok
s_branch L_pc2
L_pc2_ok:
L_pc_ok:
v_readlane_b32 s30, v208, 10
v_readlane_b32 s89, v206, 10
v_readlane_b32 s90, v207, 10
s_nop 0
s_add_u32 s82, s30, s87
s_add_u32 s81, s30, s88
s_nop 2
s_mov_b32 m0, s82
s_nop 0
buffer_load_dwordx4 v212, s[44:47], s89 offen offset:0 lds
buffer_load_dwordx4 v213, s[44:47], s89 offen offset:1024 lds
buffer_load_dwordx4 v214, s[44:47], s89 offen offset:2048 lds
buffer_load_dwordx4 v215, s[44:47], s89 offen offset:3072 lds
s_mov_b32 m0, s81
s_nop 0
buffer_load_dwordx4 v216, s[64:67], s90 offen offset:0 lds
buffer_load_dwordx4 v217, s[64:67], s90 offen offset:1024 lds
buffer_load_dwordx4 v218, s[64:67], s90 offen offset:2048 lds
buffer_load_dwordx4 v219, s[64:67], s90 offen offset:3072 lds
s_mov_b32 s92, 11
v_readlane_b32 s30, v208, s92
v_readlane_b32 s89, v206, s92
v_readlane_b32 s90, v207, s92
s_nop 0
s_add_u32 s82, s30, s87
s_add_u32 s81, s30, s88
s_mov_b32 m0, s82
L_g2lloop:
s_waitcnt vmcnt(24)
s_barrier
buffer_load_dwordx4 v212, s[44:47], s89 offen offset:0 lds
s_add_u32 s92, s92, 1
buffer_load_dwordx4 v213, s[44:47], s89 offen offset:1024 lds
v_readlane_b32 s30, v208, s92
buffer_load_dwordx4 v214, s[44:47], s89 offen offset:2048 lds
v_readlane_b32 s34, v207, s92
buffer_load_dwordx4 v215, s[44:47], s89 offen offset:3072 lds
s_mov_b32 m0, s81
v_readlane_b32 s89, v206, s92
buffer_load_dwordx4 v216, s[64:67], s90 offen offset:0 lds
s_add_u32 s82, s30, s87
buffer_load_dwordx4 v217, s[64:67], s90 offen offset:1024 lds
s_add_u32 s35, s30, s88
buffer_load_dwordx4 v218, s[64:67], s90 offen offset:2048 lds
s_cmp_lt_u32 s92, 24
buffer_load_dwordx4 v219, s[64:67], s90 offen offset:3072 lds
s_mov_b32 m0, s82
s_mov_b32 s90, s34
s_mov_b32 s81, s35
s_cbranch_scc1 L_g2lloop
s_waitcnt vmcnt(24)
s_barrier
s_cmp_eq_u32 s95, 0
s_cbranch_scc0 L_nolk
v_mov_b32 v5, 0
buffer_load_dword v231, v5, s[76:79], 0 offen offset:128 sc1
L_nolk:
buffer_load_dwordx4 v212, s[44:47], s89 offen offset:0 lds
s_add_u32 s92, s92, 1
buffer_load_dwordx4 v213, s[44:47], s89 offen offset:1024 lds
v_readlane_b32 s30, v208, s92
buffer_load_dwordx4 v214, s[44:47], s89 offen offset:2048 lds
v_readlane_b32 s34, v207, s92
buffer_load_dwordx4 v215, s[44:47], s89 offen offset:3072 lds
s_mov_b32 m0, s81
v_readlane_b32 s89, v206, s92
buffer_load_dwordx4 v216, s[64:67], s90 offen offset:0 lds
s_add_u32 s82, s30, s87
buffer_load_dwordx4 v217, s[64:67], s90 offen offset:1024 lds
s_add_u32 s35, s30, s88
buffer_load_dwordx4 v218, s[64:67], s90 offen offset:2048 lds
s_cmp_lt_u32 s92, 24
buffer_load_dwordx4 v219, s[64:67], s90 offen offset:3072 lds
s_mov_b32 m0, s82
s_mov_b32 s90, s34
s_mov_b32 s81, s35
s_waitcnt vmcnt(24)
s_barrier
buffer_load_dwordx4 v212, s[44:47], s89 offen offset:0 lds
s_add_u32 s92, s92, 1
buffer_load_dwordx4 v213, s[44:47], s89 offen offset:1024 lds
v_readlane_b32 s30, v208, s92
buffer_load_dwordx4 v214, s[44:47], s89 offen offset:2048 lds
v_readlane_b32 s34, v207, s92
buffer_load_dwordx4 v215, s[44:47], s89 offen offset:3072 lds
s_mov_b32 m0, s81
v_readlane_b32 s89, v206, s92
buffer_load_dwordx4 v216, s[64:67], s90 offen offset:0 lds
s_add_u32 s82, s30, s87
buffer_load_dwordx4 v217, s[64:67], s90 offen offset:1024 lds
s_add_u32 s35, s30, s88
buffer_load_dwordx4 v218, s[64:67], s90 offen offset:2048 lds
s_cmp_lt_u32 s92, 24
buffer_load_dwordx4 v219, s[64:67], s90 offen offset:3072 lds
s_mov_b32 m0, s82
s_mov_b32 s90, s34
s_mov_b32 s81, s35
s_waitcnt vmcnt(24)
s_barrier
buffer_load_dwordx4 v212, s[44:47], s89 offen offset:0 lds
s_add_u32 s92, s92, 1
buffer_load_dwordx4 v213, s[44:47], s89 offen offset:1024 lds
v_readlane_b32 s30, v208, s92
buffer_load_dwordx4 v214, s[44:47], s89 offen offset:2048 lds
v_readlane_b32 s34, v207, s92
buffer_load_dwordx4 v215, s[44:47], s89 offen offset:3072 lds
s_mov_b32 m0, s81
v_readlane_b32 s89, v206, s92
buffer_load_dwordx4 v216, s[64:67], s90 offen offset:0 lds
s_add_u32 s82, s30, s87
buffer_load_dwordx4 v217, s[64:67], s90 offen offset:1024 lds
s_add_u32 s35, s30, s88
buffer_load_dwordx4 v218, s[64:67], s90 offen offset:2048 lds
s_cmp_lt_u32 s92, 24
buffer_load_dwordx4 v219, s[64:67], s90 offen offset:3072 lds
s_mov_b32 m0, s82
s_mov_b32 s90, s34
s_mov_b32 s81, s35
s_waitcnt vmcnt(24)
s_barrier
buffer_load_dwordx4 v212, s[44:47], s89 offen offset:0 lds
s_add_u32 s92, s92, 1
buffer_load_dwordx4 v213, s[44:47], s89 offen offset:1024 lds
v_readlane_b32 s30, v208, s92
buffer_load_dwordx4 v214, s[44:47], s89 offen offset:2048 lds
v_readlane_b32 s34, v207, s92
buffer_load_dwordx4 v215, s[44:47], s89 offen offset:3072 lds
s_mov_b32 m0, s81
v_readlane_b32 s89, v206, s92
buffer_load_dwordx4 v216, s[64:67], s90 offen offset:0 lds
s_add_u32 s82, s30, s87
buffer_load_dwordx4 v217, s[64:67], s90 offen offset:1024 lds
s_add_u32 s35, s30, s88
buffer_load_dwordx4 v218, s[64:67], s90 offen offset:2048 lds
s_cmp_lt_u32 s92, 24
buffer_load_dwordx4 v219, s[64:67], s90 offen offset:3072 lds
s_mov_b32 m0, s82
s_mov_b32 s90, s34
s_mov_b32 s81, s35
s_cmp_eq_u32 s95, 0
s_cbranch_scc0 L_g2l_next
s_mov_b32 s34, 0
L_pf:
v_readfirstlane_b32 s30, v231
s_cmp_eq_u32 s30, 256
s_cbranch_scc1 L_g2l_next
s_add_u32 s34, s34, 1
s_cmp_lt_u32 s34, 131072
s_cbranch_scc0 L_g2l_next
s_sleep 2
v_mov_b32 v5, 0
buffer_load_dword v231, v5, s[76:79], 0 offen offset:128 sc1
s_waitcnt vmcnt(0)
s_branch L_pf
L_g2l_next:
s_waitcnt vmcnt(24)
s_barrier
s_lshl_b32 s30, s95, 11
s_add_u32 m0, s30, 98304
s_mov_b32 s31, 0
buffer_load_dwordx4 v220, s[68:71], s31 offen offset:0 lds
buffer_load_dwordx4 v221, s[68:71], s31 offen offset:1024 lds
s_add_u32 m0, s88, 98304
s_mov_b32 s31, 0
buffer_load_dwordx4 v222, s[48:51], s31 offen offset:0 lds
buffer_load_dwordx4 v223, s[48:51], s31 offen offset:1024 lds
buffer_load_dwordx4 v224, s[48:51], s31 offen offset:2048 lds
buffer_load_dwordx4 v225, s[48:51], s31 offen offset:3072 lds
s_waitcnt vmcnt(22)
s_barrier
s_lshl_b32 s30, s95, 11
s_add_u32 m0, s30, 131072
s_mov_b32 s31, 128
buffer_load_dwordx4 v220, s[68:71], s31 offen offset:0 lds
buffer_load_dwordx4 v221, s[68:71], s31 offen offset:1024 lds
s_add_u32 m0, s88, 131072
s_mov_b32 s31, 2097152
buffer_load_dwordx4 v222, s[48:51], s31 offen offset:0 lds
buffer_load_dwordx4 v223, s[48:51], s31 offen offset:1024 lds
buffer_load_dwordx4 v224, s[48:51], s31 offen offset:2048 lds
buffer_load_dwordx4 v225, s[48:51], s31 offen offset:3072 lds
s_waitcnt vmcnt(20)
s_barrier
s_lshl_b32 s30, s95, 11
s_add_u32 m0, s30, 0
s_mov_b32 s31, 0
buffer_load_dwordx4 v220, s[72:75], s31 offen offset:0 lds
buffer_load_dwordx4 v221, s[72:75], s31 offen offset:1024 lds
s_add_u32 m0, s88, 0
s_mov_b32 s31, 4194304
buffer_load_dwordx4 v222, s[48:51], s31 offen offset:0 lds
buffer_load_dwordx4 v223, s[48:51], s31 offen offset:1024 lds
buffer_load_dwordx4 v224, s[48:51], s31 offen offset:2048 lds
buffer_load_dwordx4 v225, s[48:51], s31 offen offset:3072 lds
s_waitcnt vmcnt(18)
s_barrier
s_lshl_b32 s30, s95, 11
s_add_u32 m0, s30, 32768
s_mov_b32 s31, 128
buffer_load_dwordx4 v220, s[72:75], s31 offen offset:0 lds
buffer_load_dwordx4 v221, s[72:75], s31 offen offset:1024 lds
s_add_u32 m0, s88, 32768
s_mov_b32 s31, 6291456
buffer_load_dwordx4 v222, s[48:51], s31 offen offset:0 lds
buffer_load_dwordx4 v223, s[48:51], s31 offen offset:1024 lds
buffer_load_dwordx4 v224, s[48:51], s31 offen offset:2048 lds
buffer_load_dwordx4 v225, s[48:51], s31 offen offset:3072 lds
s_waitcnt vmcnt(18)
s_barrier
s_waitcnt vmcnt(12)
s_barrier
s_waitcnt vmcnt(6)
s_barrier
s_waitcnt vmcnt(0)
s_barrier
s_waitcnt vmcnt(0)
s_barrier
L_fin:
L_end:
s_endpgm
L_code_end:
.fill 64, 4, 0xbf800000
.section .rodata,"a"
.p2align 6
.amdhsa_kernel gated_mix__spectral_fnet__dense_activation_relu__prompt_kernel
  .amdhsa_next_free_vgpr 248
  .amdhsa_next_free_sgpr 102
  .amdhsa_accum_offset 248
  .amdhsa_group_segment_fixed_size 0
  .amdhsa_kernarg_size 96
  .amdhsa_user_sgpr_count 2
  .amdhsa_user_sgpr_kernarg_segment_ptr 1
  .amdhsa_system_sgpr_workgroup_id_x 1
.end_amdhsa_kernel
```
